```python
import torch

def _softmax(x, axis=-1):
    return torch.softmax(x, dim=axis)
def _gelu(x):
    return torch.nn.functional.gelu(x, approximate="tanh")
def _silu(x):
    return torch.nn.functional.silu(x)
def _sigmoid(x):
    return torch.sigmoid(x)
def _layernorm(x, axis=-1, eps=1e-5):
    m = x.mean(dim=axis, keepdim=True)
    v = x.var(dim=axis, keepdim=True, unbiased=False)
    return (x - m) / torch.sqrt(v + eps)
def _scatter_add(tgt, idx, src, axis=0):
    return tgt.clone().index_add_(axis, idx, src)
def _segment_sum(src, seg, n):
    out = torch.zeros((n,) + src.shape[1:], dtype=src.dtype)
    return out.index_add_(0, seg, src)
def _pad(x, pw):
    flat = tuple(v for pair in reversed(pw) for v in pair)
    return torch.nn.functional.pad(x, flat)

kernel_name = 'standalone__standard_2d_1d_3d_conv__vision'

def setup_inputs():

    _w = (lambda a: (lambda t: t.to(torch.bfloat16) if t.is_floating_point() else t)(torch.as_tensor(a)))
    H = W = 256
    C = 384
    K = 1
    return {
        "x": _w((lambda *s: torch.randn(*s, dtype=torch.bfloat16) * 0.05)(1, H, W, C)),
        "w": _w((lambda *s: torch.randn(*s, dtype=torch.bfloat16) * 0.05)(K, K, C, C)),
        "b": _w((lambda *s: torch.randn(*s, dtype=torch.bfloat16) * 0.05)(C)),
    }

def reference(x, w, b):
    B, H, W, Cin = x.shape
    K = w.shape[0]
    pl = (K - 1) // 2
    pr = K // 2
    xp = _pad(x, ((0, 0), (pl, pr), (pl, pr), (0, 0)))
    out = sum(
        torch.einsum('bhwc,cd->bhwd', xp[:, i:i+H, j:j+W, :], w[i, j])
        for i in range(K) for j in range(K)
    )
    return out + b[None, None, None, :]
```

```asm
; @launch grid=(256,1,1) block=(512,1,1) lds=147456
.amdgcn_target "amdgcn-amd-amdhsa--gfx950"
.text
.globl standalone__standard_2d_1d_3d_conv__vision_kernel
.p2align 8
.type standalone__standard_2d_1d_3d_conv__vision_kernel,@function
standalone__standard_2d_1d_3d_conv__vision_kernel:
    s_cmp_ge_u32 s2, 256
    s_cbranch_scc1 L_end
    s_load_dwordx8 s[4:11], s[0:1], 0
    v_lshrrev_b32 v238, 6, v0
    v_and_b32 v239, 63, v0
    s_nop 0
    v_readfirstlane_b32 s28, v238
    s_mul_i32 s29, s2, 196608
    s_waitcnt lgkmcnt(0)
    s_mov_b32 s12, s4
    s_and_b32 s13, s5, 0xffff
    s_mov_b32 s14, 50331648
    s_mov_b32 s15, 0x00020000
    s_mov_b32 s16, s6
    s_and_b32 s17, s7, 0xffff
    s_mov_b32 s18, 294912
    s_mov_b32 s19, 0x00020000
    s_mov_b32 s20, s8
    s_and_b32 s21, s9, 0xffff
    s_mov_b32 s22, 768
    s_mov_b32 s23, 0x00020000
    s_mov_b32 s24, s10
    s_and_b32 s25, s11, 0xffff
    s_mov_b32 s26, 50331648
    s_mov_b32 s27, 0x00020000
    s_cmp_ge_u32 s28, 4
    s_cbranch_scc1 L_b
    s_and_b32 s30, s28, 3
    s_mul_i32 s30, s30, 384
    v_add_u32 v240, s30, v239
    v_lshrrev_b32 v241, 4, v240
    v_mul_u32_u24 v242, 171, v241
    v_lshrrev_b32 v242, 9, v242
    v_mul_u32_u24 v244, 48, v242
    v_sub_u32 v243, v240, v244
    v_and_b32 v244, 3, v242
    v_lshlrev_b32 v244, 1, v244
    v_and_b32 v241, 8, v242
    v_or_b32 v244, v244, v241
    v_xor_b32 v244, v243, v244
    v_lshlrev_b32 v244, 4, v244
    v_mul_u32_u24 v216, 768, v242
    v_add_u32 v216, v216, v244
    v_add_u32 v240, s30, v239
    v_add_u32 v240, 64, v240
    v_lshrrev_b32 v241, 4, v240
    v_mul_u32_u24 v242, 171, v241
    v_lshrrev_b32 v242, 9, v242
    v_mul_u32_u24 v244, 48, v242
    v_sub_u32 v243, v240, v244
    v_and_b32 v244, 3, v242
    v_lshlrev_b32 v244, 1, v244
    v_and_b32 v241, 8, v242
    v_or_b32 v244, v244, v241
    v_xor_b32 v244, v243, v244
    v_lshlrev_b32 v244, 4, v244
    v_mul_u32_u24 v217, 768, v242
    v_add_u32 v217, v217, v244
    v_add_u32 v240, s30, v239
    v_add_u32 v240, 128, v240
    v_lshrrev_b32 v241, 4, v240
    v_mul_u32_u24 v242, 171, v241
    v_lshrrev_b32 v242, 9, v242
    v_mul_u32_u24 v244, 48, v242
    v_sub_u32 v243, v240, v244
    v_and_b32 v244, 3, v242
    v_lshlrev_b32 v244, 1, v244
    v_and_b32 v241, 8, v242
    v_or_b32 v244, v244, v241
    v_xor_b32 v244, v243, v244
    v_lshlrev_b32 v244, 4, v244
    v_mul_u32_u24 v218, 768, v242
    v_add_u32 v218, v218, v244
    v_add_u32 v240, s30, v239
    v_add_u32 v240, 192, v240
    v_lshrrev_b32 v241, 4, v240
    v_mul_u32_u24 v242, 171, v241
    v_lshrrev_b32 v242, 9, v242
    v_mul_u32_u24 v244, 48, v242
    v_sub_u32 v243, v240, v244
    v_and_b32 v244, 3, v242
    v_lshlrev_b32 v244, 1, v244
    v_and_b32 v241, 8, v242
    v_or_b32 v244, v244, v241
    v_xor_b32 v244, v243, v244
    v_lshlrev_b32 v244, 4, v244
    v_mul_u32_u24 v219, 768, v242
    v_add_u32 v219, v219, v244
    v_add_u32 v240, s30, v239
    v_add_u32 v240, 256, v240
    v_lshrrev_b32 v241, 4, v240
    v_mul_u32_u24 v242, 171, v241
    v_lshrrev_b32 v242, 9, v242
    v_mul_u32_u24 v244, 48, v242
    v_sub_u32 v243, v240, v244
    v_and_b32 v244, 3, v242
    v_lshlrev_b32 v244, 1, v244
    v_and_b32 v241, 8, v242
    v_or_b32 v244, v244, v241
    v_xor_b32 v244, v243, v244
    v_lshlrev_b32 v244, 4, v244
    v_mul_u32_u24 v220, 768, v242
    v_add_u32 v220, v220, v244
    v_add_u32 v240, s30, v239
    v_add_u32 v240, 320, v240
    v_lshrrev_b32 v241, 4, v240
    v_mul_u32_u24 v242, 171, v241
    v_lshrrev_b32 v242, 9, v242
    v_mul_u32_u24 v244, 48, v242
    v_sub_u32 v243, v240, v244
    v_and_b32 v244, 3, v242
    v_lshlrev_b32 v244, 1, v244
    v_and_b32 v241, 8, v242
    v_or_b32 v244, v244, v241
    v_xor_b32 v244, v243, v244
    v_lshlrev_b32 v244, 4, v244
    v_mul_u32_u24 v221, 768, v242
    v_add_u32 v221, v221, v244
    v_and_b32 v240, 15, v239
    v_lshrrev_b32 v241, 4, v239
    v_add_u32 v242, 0, v241
    v_xor_b32 v242, v242, v240
    v_lshlrev_b32 v242, 4, v242
    v_mul_u32_u24 v212, 768, v240
    v_add_u32 v212, v212, v242
    v_add_u32 v242, 4, v241
    v_xor_b32 v242, v242, v240
    v_lshlrev_b32 v242, 4, v242
    v_mul_u32_u24 v213, 768, v240
    v_add_u32 v213, v213, v242
    v_add_u32 v242, 8, v241
    v_xor_b32 v242, v242, v240
    v_lshlrev_b32 v242, 4, v242
    v_mul_u32_u24 v214, 768, v240
    v_add_u32 v214, v214, v242
    v_add_u32 v242, 12, v241
    v_xor_b32 v242, v242, v240
    v_lshlrev_b32 v242, 4, v242
    v_mul_u32_u24 v215, 768, v240
    v_add_u32 v215, v215, v242
    s_mul_i32 s31, s28, 96
    v_mul_u32_u24 v225, 768, v240
    v_mul_u32_u24 v242, 24, v241
    v_add_u32 v225, v225, v242
    v_add_u32 v225, s31, v225
    v_add_u32 v243, s31, v242
    v_lshrrev_b32 v244, 2, v240
    v_and_b32 v245, 3, v240
    v_lshlrev_b32 v242, 3, v241
    v_add_u32 v242, v242, v244
    v_and_b32 v240, 1, v241
    v_lshlrev_b32 v240, 2, v240
    v_or_b32 v240, v240, v244
    v_lshlrev_b32 v240, 5, v240
    v_mul_u32_u24 v242, 768, v242
    v_mul_u32_u24 v245, 24, v245
    v_add_u32 v245, s31, v245
    v_add_u32 v222, 0, v245
    v_xor_b32 v222, v222, v240
    v_add_u32 v222, v222, v242
    v_add_u32 v222, 73728, v222
    v_add_u32 v223, 8, v245
    v_xor_b32 v223, v223, v240
    v_add_u32 v223, v223, v242
    v_add_u32 v223, 73728, v223
    v_add_u32 v224, 16, v245
    v_xor_b32 v224, v224, v240
    v_add_u32 v224, v224, v242
    v_add_u32 v224, 73728, v224
    s_and_b32 s32, s28, 3
    s_mul_i32 s32, s32, 6144
    buffer_load_dwordx4 v[226:229], v243, s[20:23], 0 offen
    buffer_load_dwordx2 v[230:231], v243, s[20:23], 0 offen offset:16
    s_mov_b32 s33, 0
    s_add_u32 m0, s32, 73728
    s_nop 0
    buffer_load_dwordx4 v216, s[16:19], s33 offen lds
    s_add_u32 m0, s32, 74752
    s_nop 0
    buffer_load_dwordx4 v217, s[16:19], s33 offen lds
    s_add_u32 m0, s32, 75776
    s_nop 0
    buffer_load_dwordx4 v218, s[16:19], s33 offen lds
    s_add_u32 m0, s32, 76800
    s_nop 0
    buffer_load_dwordx4 v219, s[16:19], s33 offen lds
    s_add_u32 m0, s32, 77824
    s_nop 0
    buffer_load_dwordx4 v220, s[16:19], s33 offen lds
    s_add_u32 m0, s32, 78848
    s_nop 0
    buffer_load_dwordx4 v221, s[16:19], s33 offen lds
    s_mov_b32 s33, 24576
    s_add_u32 m0, s32, 98304
    s_nop 0
    buffer_load_dwordx4 v216, s[16:19], s33 offen lds
    s_add_u32 m0, s32, 99328
    s_nop 0
    buffer_load_dwordx4 v217, s[16:19], s33 offen lds
    s_add_u32 m0, s32, 100352
    s_nop 0
    buffer_load_dwordx4 v218, s[16:19], s33 offen lds
    s_add_u32 m0, s32, 101376
    s_nop 0
    buffer_load_dwordx4 v219, s[16:19], s33 offen lds
    s_add_u32 m0, s32, 102400
    s_nop 0
    buffer_load_dwordx4 v220, s[16:19], s33 offen lds
    s_add_u32 m0, s32, 103424
    s_nop 0
    buffer_load_dwordx4 v221, s[16:19], s33 offen lds
    s_mov_b32 s33, 49152
    s_add_u32 m0, s32, 122880
    s_nop 0
    buffer_load_dwordx4 v216, s[16:19], s33 offen lds
    s_add_u32 m0, s32, 123904
    s_nop 0
    buffer_load_dwordx4 v217, s[16:19], s33 offen lds
    s_add_u32 m0, s32, 124928
    s_nop 0
    buffer_load_dwordx4 v218, s[16:19], s33 offen lds
    s_add_u32 m0, s32, 125952
    s_nop 0
    buffer_load_dwordx4 v219, s[16:19], s33 offen lds
    s_add_u32 m0, s32, 126976
    s_nop 0
    buffer_load_dwordx4 v220, s[16:19], s33 offen lds
    s_add_u32 m0, s32, 128000
    s_nop 0
    buffer_load_dwordx4 v221, s[16:19], s33 offen lds
    s_waitcnt vmcnt(18)
    v_lshlrev_b32 v168, 16, v226
    v_and_b32 v169, 0xffff0000, v226
    v_lshlrev_b32 v170, 16, v227
    v_and_b32 v171, 0xffff0000, v227
    v_lshlrev_b32 v172, 16, v228
    v_and_b32 v173, 0xffff0000, v228
    v_lshlrev_b32 v174, 16, v229
    v_and_b32 v175, 0xffff0000, v229
    v_lshlrev_b32 v176, 16, v230
    v_and_b32 v177, 0xffff0000, v230
    v_lshlrev_b32 v178, 16, v231
    v_and_b32 v179, 0xffff0000, v231
    s_waitcnt vmcnt(12)
    s_barrier
    ds_read_b64_tr_b16 v[0:1], v222 offset:0
    ds_read_b64_tr_b16 v[2:3], v222 offset:3072
    ds_read_b64_tr_b16 v[4:5], v223 offset:0
    ds_read_b64_tr_b16 v[6:7], v223 offset:3072
    ds_read_b64_tr_b16 v[8:9], v224 offset:0
    ds_read_b64_tr_b16 v[10:11], v224 offset:3072
    v_add_u32 v222, 24576, v222
    v_add_u32 v223, 24576, v223
    v_add_u32 v224, 24576, v224
    ds_read_b128 v[180:183], v212 offset:0
    ds_read_b128 v[184:187], v212 offset:12288
    ds_read_b128 v[188:191], v212 offset:24576
    ds_read_b128 v[192:195], v212 offset:36864
    s_waitcnt lgkmcnt(0)
    v_mfma_f32_16x16x32_bf16 v[144:147], v[0:3], v[180:183], v[168:171]
    v_mfma_f32_16x16x32_bf16 v[148:151], v[4:7], v[180:183], v[172:175]
    v_mfma_f32_16x16x32_bf16 v[152:155], v[8:11], v[180:183], v[176:179]
    v_mfma_f32_16x16x32_bf16 v[156:159], v[0:3], v[184:187], v[168:171]
    v_mfma_f32_16x16x32_bf16 v[160:163], v[4:7], v[184:187], v[172:175]
    v_mfma_f32_16x16x32_bf16 v[164:167], v[8:11], v[184:187], v[176:179]
    v_mfma_f32_16x16x32_bf16 v[196:199], v[0:3], v[188:191], v[168:171]
    v_mfma_f32_16x16x32_bf16 v[200:203], v[4:7], v[188:191], v[172:175]
    v_mfma_f32_16x16x32_bf16 v[204:207], v[8:11], v[188:191], v[176:179]
    v_mfma_f32_16x16x32_bf16 v[208:211], v[0:3], v[192:195], v[168:171]
    v_mfma_f32_16x16x32_bf16 v[226:229], v[4:7], v[192:195], v[172:175]
    v_mfma_f32_16x16x32_bf16 v[230:233], v[8:11], v[192:195], v[176:179]
    s_waitcnt vmcnt(6)
    s_barrier
    s_mov_b32 s33, 73728
    s_add_u32 m0, s32, 73728
    s_nop 0
    buffer_load_dwordx4 v216, s[16:19], s33 offen lds
    s_add_u32 m0, s32, 74752
    s_nop 0
    buffer_load_dwordx4 v217, s[16:19], s33 offen lds
    s_add_u32 m0, s32, 75776
    s_nop 0
    buffer_load_dwordx4 v218, s[16:19], s33 offen lds
    s_add_u32 m0, s32, 76800
    s_nop 0
    buffer_load_dwordx4 v219, s[16:19], s33 offen lds
    s_add_u32 m0, s32, 77824
    s_nop 0
    buffer_load_dwordx4 v220, s[16:19], s33 offen lds
    s_add_u32 m0, s32, 78848
    s_nop 0
    buffer_load_dwordx4 v221, s[16:19], s33 offen lds
    ds_read_b64_tr_b16 v[12:13], v222 offset:0
    ds_read_b64_tr_b16 v[14:15], v222 offset:3072
    ds_read_b64_tr_b16 v[16:17], v223 offset:0
    ds_read_b64_tr_b16 v[18:19], v223 offset:3072
    ds_read_b64_tr_b16 v[20:21], v224 offset:0
    ds_read_b64_tr_b16 v[22:23], v224 offset:3072
    v_add_u32 v222, 24576, v222
    v_add_u32 v223, 24576, v223
    v_add_u32 v224, 24576, v224
    ds_read_b128 v[180:183], v213 offset:0
    ds_read_b128 v[184:187], v213 offset:12288
    ds_read_b128 v[188:191], v213 offset:24576
    ds_read_b128 v[192:195], v213 offset:36864
    s_waitcnt lgkmcnt(0)
    v_mfma_f32_16x16x32_bf16 v[144:147], v[12:15], v[180:183], v[144:147]
    v_mfma_f32_16x16x32_bf16 v[148:151], v[16:19], v[180:183], v[148:151]
    v_mfma_f32_16x16x32_bf16 v[152:155], v[20:23], v[180:183], v[152:155]
    v_mfma_f32_16x16x32_bf16 v[156:159], v[12:15], v[184:187], v[156:159]
    v_mfma_f32_16x16x32_bf16 v[160:163], v[16:19], v[184:187], v[160:163]
    v_mfma_f32_16x16x32_bf16 v[164:167], v[20:23], v[184:187], v[164:167]
    v_mfma_f32_16x16x32_bf16 v[196:199], v[12:15], v[188:191], v[196:199]
    v_mfma_f32_16x16x32_bf16 v[200:203], v[16:19], v[188:191], v[200:203]
    v_mfma_f32_16x16x32_bf16 v[204:207], v[20:23], v[188:191], v[204:207]
    v_mfma_f32_16x16x32_bf16 v[208:211], v[12:15], v[192:195], v[208:211]
    v_mfma_f32_16x16x32_bf16 v[226:229], v[16:19], v[192:195], v[226:229]
    v_mfma_f32_16x16x32_bf16 v[230:233], v[20:23], v[192:195], v[230:233]
    s_waitcnt vmcnt(6)
    s_barrier
    s_mov_b32 s33, 98304
    s_add_u32 m0, s32, 98304
    s_nop 0
    buffer_load_dwordx4 v216, s[16:19], s33 offen lds
    s_add_u32 m0, s32, 99328
    s_nop 0
    buffer_load_dwordx4 v217, s[16:19], s33 offen lds
    s_add_u32 m0, s32, 100352
    s_nop 0
    buffer_load_dwordx4 v218, s[16:19], s33 offen lds
    s_add_u32 m0, s32, 101376
    s_nop 0
    buffer_load_dwordx4 v219, s[16:19], s33 offen lds
    s_add_u32 m0, s32, 102400
    s_nop 0
    buffer_load_dwordx4 v220, s[16:19], s33 offen lds
    s_add_u32 m0, s32, 103424
    s_nop 0
    buffer_load_dwordx4 v221, s[16:19], s33 offen lds
    ds_read_b64_tr_b16 v[24:25], v222 offset:0
    ds_read_b64_tr_b16 v[26:27], v222 offset:3072
    ds_read_b64_tr_b16 v[28:29], v223 offset:0
    ds_read_b64_tr_b16 v[30:31], v223 offset:3072
    ds_read_b64_tr_b16 v[32:33], v224 offset:0
    ds_read_b64_tr_b16 v[34:35], v224 offset:3072
    v_add_u32 v222, 4294918144, v222
    v_add_u32 v223, 4294918144, v223
    v_add_u32 v224, 4294918144, v224
    ds_read_b128 v[180:183], v214 offset:0
    ds_read_b128 v[184:187], v214 offset:12288
    ds_read_b128 v[188:191], v214 offset:24576
    ds_read_b128 v[192:195], v214 offset:36864
    s_waitcnt lgkmcnt(0)
    v_mfma_f32_16x16x32_bf16 v[144:147], v[24:27], v[180:183], v[144:147]
    v_mfma_f32_16x16x32_bf16 v[148:151], v[28:31], v[180:183], v[148:151]
    v_mfma_f32_16x16x32_bf16 v[152:155], v[32:35], v[180:183], v[152:155]
    v_mfma_f32_16x16x32_bf16 v[156:159], v[24:27], v[184:187], v[156:159]
    v_mfma_f32_16x16x32_bf16 v[160:163], v[28:31], v[184:187], v[160:163]
    v_mfma_f32_16x16x32_bf16 v[164:167], v[32:35], v[184:187], v[164:167]
    v_mfma_f32_16x16x32_bf16 v[196:199], v[24:27], v[188:191], v[196:199]
    v_mfma_f32_16x16x32_bf16 v[200:203], v[28:31], v[188:191], v[200:203]
    v_mfma_f32_16x16x32_bf16 v[204:207], v[32:35], v[188:191], v[204:207]
    v_mfma_f32_16x16x32_bf16 v[208:211], v[24:27], v[192:195], v[208:211]
    v_mfma_f32_16x16x32_bf16 v[226:229], v[28:31], v[192:195], v[226:229]
    v_mfma_f32_16x16x32_bf16 v[230:233], v[32:35], v[192:195], v[230:233]
    s_waitcnt vmcnt(6)
    s_barrier
    s_mov_b32 s33, 122880
    s_add_u32 m0, s32, 122880
    s_nop 0
    buffer_load_dwordx4 v216, s[16:19], s33 offen lds
    s_add_u32 m0, s32, 123904
    s_nop 0
    buffer_load_dwordx4 v217, s[16:19], s33 offen lds
    s_add_u32 m0, s32, 124928
    s_nop 0
    buffer_load_dwordx4 v218, s[16:19], s33 offen lds
    s_add_u32 m0, s32, 125952
    s_nop 0
    buffer_load_dwordx4 v219, s[16:19], s33 offen lds
    s_add_u32 m0, s32, 126976
    s_nop 0
    buffer_load_dwordx4 v220, s[16:19], s33 offen lds
    s_add_u32 m0, s32, 128000
    s_nop 0
    buffer_load_dwordx4 v221, s[16:19], s33 offen lds
    ds_read_b64_tr_b16 v[36:37], v222 offset:0
    ds_read_b64_tr_b16 v[38:39], v222 offset:3072
    ds_read_b64_tr_b16 v[40:41], v223 offset:0
    ds_read_b64_tr_b16 v[42:43], v223 offset:3072
    ds_read_b64_tr_b16 v[44:45], v224 offset:0
    ds_read_b64_tr_b16 v[46:47], v224 offset:3072
    v_add_u32 v222, 24576, v222
    v_add_u32 v223, 24576, v223
    v_add_u32 v224, 24576, v224
    ds_read_b128 v[180:183], v215 offset:0
    ds_read_b128 v[184:187], v215 offset:12288
    ds_read_b128 v[188:191], v215 offset:24576
    ds_read_b128 v[192:195], v215 offset:36864
    s_waitcnt lgkmcnt(0)
    v_mfma_f32_16x16x32_bf16 v[144:147], v[36:39], v[180:183], v[144:147]
    v_mfma_f32_16x16x32_bf16 v[148:151], v[40:43], v[180:183], v[148:151]
    v_mfma_f32_16x16x32_bf16 v[152:155], v[44:47], v[180:183], v[152:155]
    v_mfma_f32_16x16x32_bf16 v[156:159], v[36:39], v[184:187], v[156:159]
    v_mfma_f32_16x16x32_bf16 v[160:163], v[40:43], v[184:187], v[160:163]
    v_mfma_f32_16x16x32_bf16 v[164:167], v[44:47], v[184:187], v[164:167]
    v_mfma_f32_16x16x32_bf16 v[196:199], v[36:39], v[188:191], v[196:199]
    v_mfma_f32_16x16x32_bf16 v[200:203], v[40:43], v[188:191], v[200:203]
    v_mfma_f32_16x16x32_bf16 v[204:207], v[44:47], v[188:191], v[204:207]
    v_mfma_f32_16x16x32_bf16 v[208:211], v[36:39], v[192:195], v[208:211]
    v_mfma_f32_16x16x32_bf16 v[226:229], v[40:43], v[192:195], v[226:229]
    v_mfma_f32_16x16x32_bf16 v[230:233], v[44:47], v[192:195], v[230:233]
    s_waitcnt vmcnt(6)
    s_barrier
    s_mov_b32 s33, 147456
    s_add_u32 m0, s32, 73728
    s_nop 0
    buffer_load_dwordx4 v216, s[16:19], s33 offen lds
    s_add_u32 m0, s32, 74752
    s_nop 0
    buffer_load_dwordx4 v217, s[16:19], s33 offen lds
    s_add_u32 m0, s32, 75776
    s_nop 0
    buffer_load_dwordx4 v218, s[16:19], s33 offen lds
    s_add_u32 m0, s32, 76800
    s_nop 0
    buffer_load_dwordx4 v219, s[16:19], s33 offen lds
    s_add_u32 m0, s32, 77824
    s_nop 0
    buffer_load_dwordx4 v220, s[16:19], s33 offen lds
    s_add_u32 m0, s32, 78848
    s_nop 0
    buffer_load_dwordx4 v221, s[16:19], s33 offen lds
    ds_read_b64_tr_b16 v[48:49], v222 offset:0
    ds_read_b64_tr_b16 v[50:51], v222 offset:3072
    ds_read_b64_tr_b16 v[52:53], v223 offset:0
    ds_read_b64_tr_b16 v[54:55], v223 offset:3072
    ds_read_b64_tr_b16 v[56:57], v224 offset:0
    ds_read_b64_tr_b16 v[58:59], v224 offset:3072
    v_add_u32 v222, 24576, v222
    v_add_u32 v223, 24576, v223
    v_add_u32 v224, 24576, v224
    ds_read_b128 v[180:183], v212 offset:256
    ds_read_b128 v[184:187], v212 offset:12544
    ds_read_b128 v[188:191], v212 offset:24832
    ds_read_b128 v[192:195], v212 offset:37120
    s_waitcnt lgkmcnt(0)
    v_mfma_f32_16x16x32_bf16 v[144:147], v[48:51], v[180:183], v[144:147]
    v_mfma_f32_16x16x32_bf16 v[148:151], v[52:55], v[180:183], v[148:151]
    v_mfma_f32_16x16x32_bf16 v[152:155], v[56:59], v[180:183], v[152:155]
    v_mfma_f32_16x16x32_bf16 v[156:159], v[48:51], v[184:187], v[156:159]
    v_mfma_f32_16x16x32_bf16 v[160:163], v[52:55], v[184:187], v[160:163]
    v_mfma_f32_16x16x32_bf16 v[164:167], v[56:59], v[184:187], v[164:167]
    v_mfma_f32_16x16x32_bf16 v[196:199], v[48:51], v[188:191], v[196:199]
    v_mfma_f32_16x16x32_bf16 v[200:203], v[52:55], v[188:191], v[200:203]
    v_mfma_f32_16x16x32_bf16 v[204:207], v[56:59], v[188:191], v[204:207]
    v_mfma_f32_16x16x32_bf16 v[208:211], v[48:51], v[192:195], v[208:211]
    v_mfma_f32_16x16x32_bf16 v[226:229], v[52:55], v[192:195], v[226:229]
    v_mfma_f32_16x16x32_bf16 v[230:233], v[56:59], v[192:195], v[230:233]
    s_waitcnt vmcnt(6)
    s_barrier
    s_mov_b32 s33, 172032
    s_add_u32 m0, s32, 98304
    s_nop 0
    buffer_load_dwordx4 v216, s[16:19], s33 offen lds
    s_add_u32 m0, s32, 99328
    s_nop 0
    buffer_load_dwordx4 v217, s[16:19], s33 offen lds
    s_add_u32 m0, s32, 100352
    s_nop 0
    buffer_load_dwordx4 v218, s[16:19], s33 offen lds
    s_add_u32 m0, s32, 101376
    s_nop 0
    buffer_load_dwordx4 v219, s[16:19], s33 offen lds
    s_add_u32 m0, s32, 102400
    s_nop 0
    buffer_load_dwordx4 v220, s[16:19], s33 offen lds
    s_add_u32 m0, s32, 103424
    s_nop 0
    buffer_load_dwordx4 v221, s[16:19], s33 offen lds
    ds_read_b64_tr_b16 v[60:61], v222 offset:0
    ds_read_b64_tr_b16 v[62:63], v222 offset:3072
    ds_read_b64_tr_b16 v[64:65], v223 offset:0
    ds_read_b64_tr_b16 v[66:67], v223 offset:3072
    ds_read_b64_tr_b16 v[68:69], v224 offset:0
    ds_read_b64_tr_b16 v[70:71], v224 offset:3072
    v_add_u32 v222, 4294918144, v222
    v_add_u32 v223, 4294918144, v223
    v_add_u32 v224, 4294918144, v224
    ds_read_b128 v[180:183], v213 offset:256
    ds_read_b128 v[184:187], v213 offset:12544
    ds_read_b128 v[188:191], v213 offset:24832
    ds_read_b128 v[192:195], v213 offset:37120
    s_waitcnt lgkmcnt(0)
    v_mfma_f32_16x16x32_bf16 v[144:147], v[60:63], v[180:183], v[144:147]
    v_mfma_f32_16x16x32_bf16 v[148:151], v[64:67], v[180:183], v[148:151]
    v_mfma_f32_16x16x32_bf16 v[152:155], v[68:71], v[180:183], v[152:155]
    v_mfma_f32_16x16x32_bf16 v[156:159], v[60:63], v[184:187], v[156:159]
    v_mfma_f32_16x16x32_bf16 v[160:163], v[64:67], v[184:187], v[160:163]
    v_mfma_f32_16x16x32_bf16 v[164:167], v[68:71], v[184:187], v[164:167]
    v_mfma_f32_16x16x32_bf16 v[196:199], v[60:63], v[188:191], v[196:199]
    v_mfma_f32_16x16x32_bf16 v[200:203], v[64:67], v[188:191], v[200:203]
    v_mfma_f32_16x16x32_bf16 v[204:207], v[68:71], v[188:191], v[204:207]
    v_mfma_f32_16x16x32_bf16 v[208:211], v[60:63], v[192:195], v[208:211]
    v_mfma_f32_16x16x32_bf16 v[226:229], v[64:67], v[192:195], v[226:229]
    v_mfma_f32_16x16x32_bf16 v[230:233], v[68:71], v[192:195], v[230:233]
    s_waitcnt vmcnt(6)
    s_barrier
    s_mov_b32 s33, 196608
    s_add_u32 m0, s32, 122880
    s_nop 0
    buffer_load_dwordx4 v216, s[16:19], s33 offen lds
    s_add_u32 m0, s32, 123904
    s_nop 0
    buffer_load_dwordx4 v217, s[16:19], s33 offen lds
    s_add_u32 m0, s32, 124928
    s_nop 0
    buffer_load_dwordx4 v218, s[16:19], s33 offen lds
    s_add_u32 m0, s32, 125952
    s_nop 0
    buffer_load_dwordx4 v219, s[16:19], s33 offen lds
    s_add_u32 m0, s32, 126976
    s_nop 0
    buffer_load_dwordx4 v220, s[16:19], s33 offen lds
    s_add_u32 m0, s32, 128000
    s_nop 0
    buffer_load_dwordx4 v221, s[16:19], s33 offen lds
    ds_read_b64_tr_b16 v[72:73], v222 offset:0
    ds_read_b64_tr_b16 v[74:75], v222 offset:3072
    ds_read_b64_tr_b16 v[76:77], v223 offset:0
    ds_read_b64_tr_b16 v[78:79], v223 offset:3072
    ds_read_b64_tr_b16 v[80:81], v224 offset:0
    ds_read_b64_tr_b16 v[82:83], v224 offset:3072
    v_add_u32 v222, 24576, v222
    v_add_u32 v223, 24576, v223
    v_add_u32 v224, 24576, v224
    ds_read_b128 v[180:183], v214 offset:256
    ds_read_b128 v[184:187], v214 offset:12544
    ds_read_b128 v[188:191], v214 offset:24832
    ds_read_b128 v[192:195], v214 offset:37120
    s_waitcnt lgkmcnt(0)
    v_mfma_f32_16x16x32_bf16 v[144:147], v[72:75], v[180:183], v[144:147]
    v_mfma_f32_16x16x32_bf16 v[148:151], v[76:79], v[180:183], v[148:151]
    v_mfma_f32_16x16x32_bf16 v[152:155], v[80:83], v[180:183], v[152:155]
    v_mfma_f32_16x16x32_bf16 v[156:159], v[72:75], v[184:187], v[156:159]
    v_mfma_f32_16x16x32_bf16 v[160:163], v[76:79], v[184:187], v[160:163]
    v_mfma_f32_16x16x32_bf16 v[164:167], v[80:83], v[184:187], v[164:167]
    v_mfma_f32_16x16x32_bf16 v[196:199], v[72:75], v[188:191], v[196:199]
    v_mfma_f32_16x16x32_bf16 v[200:203], v[76:79], v[188:191], v[200:203]
    v_mfma_f32_16x16x32_bf16 v[204:207], v[80:83], v[188:191], v[204:207]
    v_mfma_f32_16x16x32_bf16 v[208:211], v[72:75], v[192:195], v[208:211]
    v_mfma_f32_16x16x32_bf16 v[226:229], v[76:79], v[192:195], v[226:229]
    v_mfma_f32_16x16x32_bf16 v[230:233], v[80:83], v[192:195], v[230:233]
    s_waitcnt vmcnt(6)
    s_barrier
    s_mov_b32 s33, 221184
    s_add_u32 m0, s32, 73728
    s_nop 0
    buffer_load_dwordx4 v216, s[16:19], s33 offen lds
    s_add_u32 m0, s32, 74752
    s_nop 0
    buffer_load_dwordx4 v217, s[16:19], s33 offen lds
    s_add_u32 m0, s32, 75776
    s_nop 0
    buffer_load_dwordx4 v218, s[16:19], s33 offen lds
    s_add_u32 m0, s32, 76800
    s_nop 0
    buffer_load_dwordx4 v219, s[16:19], s33 offen lds
    s_add_u32 m0, s32, 77824
    s_nop 0
    buffer_load_dwordx4 v220, s[16:19], s33 offen lds
    s_add_u32 m0, s32, 78848
    s_nop 0
    buffer_load_dwordx4 v221, s[16:19], s33 offen lds
    ds_read_b64_tr_b16 v[84:85], v222 offset:0
    ds_read_b64_tr_b16 v[86:87], v222 offset:3072
    ds_read_b64_tr_b16 v[88:89], v223 offset:0
    ds_read_b64_tr_b16 v[90:91], v223 offset:3072
    ds_read_b64_tr_b16 v[92:93], v224 offset:0
    ds_read_b64_tr_b16 v[94:95], v224 offset:3072
    v_add_u32 v222, 24576, v222
    v_add_u32 v223, 24576, v223
    v_add_u32 v224, 24576, v224
    ds_read_b128 v[180:183], v215 offset:256
    ds_read_b128 v[184:187], v215 offset:12544
    ds_read_b128 v[188:191], v215 offset:24832
    ds_read_b128 v[192:195], v215 offset:37120
    s_waitcnt lgkmcnt(0)
    v_mfma_f32_16x16x32_bf16 v[144:147], v[84:87], v[180:183], v[144:147]
    v_mfma_f32_16x16x32_bf16 v[148:151], v[88:91], v[180:183], v[148:151]
    v_mfma_f32_16x16x32_bf16 v[152:155], v[92:95], v[180:183], v[152:155]
    v_mfma_f32_16x16x32_bf16 v[156:159], v[84:87], v[184:187], v[156:159]
    v_mfma_f32_16x16x32_bf16 v[160:163], v[88:91], v[184:187], v[160:163]
    v_mfma_f32_16x16x32_bf16 v[164:167], v[92:95], v[184:187], v[164:167]
    v_mfma_f32_16x16x32_bf16 v[196:199], v[84:87], v[188:191], v[196:199]
    v_mfma_f32_16x16x32_bf16 v[200:203], v[88:91], v[188:191], v[200:203]
    v_mfma_f32_16x16x32_bf16 v[204:207], v[92:95], v[188:191], v[204:207]
    v_mfma_f32_16x16x32_bf16 v[208:211], v[84:87], v[192:195], v[208:211]
    v_mfma_f32_16x16x32_bf16 v[226:229], v[88:91], v[192:195], v[226:229]
    v_mfma_f32_16x16x32_bf16 v[230:233], v[92:95], v[192:195], v[230:233]
    s_waitcnt vmcnt(6)
    s_barrier
    s_mov_b32 s33, 245760
    s_add_u32 m0, s32, 98304
    s_nop 0
    buffer_load_dwordx4 v216, s[16:19], s33 offen lds
    s_add_u32 m0, s32, 99328
    s_nop 0
    buffer_load_dwordx4 v217, s[16:19], s33 offen lds
    s_add_u32 m0, s32, 100352
    s_nop 0
    buffer_load_dwordx4 v218, s[16:19], s33 offen lds
    s_add_u32 m0, s32, 101376
    s_nop 0
    buffer_load_dwordx4 v219, s[16:19], s33 offen lds
    s_add_u32 m0, s32, 102400
    s_nop 0
    buffer_load_dwordx4 v220, s[16:19], s33 offen lds
    s_add_u32 m0, s32, 103424
    s_nop 0
    buffer_load_dwordx4 v221, s[16:19], s33 offen lds
    ds_read_b64_tr_b16 v[96:97], v222 offset:0
    ds_read_b64_tr_b16 v[98:99], v222 offset:3072
    ds_read_b64_tr_b16 v[100:101], v223 offset:0
    ds_read_b64_tr_b16 v[102:103], v223 offset:3072
    ds_read_b64_tr_b16 v[104:105], v224 offset:0
    ds_read_b64_tr_b16 v[106:107], v224 offset:3072
    v_add_u32 v222, 4294918144, v222
    v_add_u32 v223, 4294918144, v223
    v_add_u32 v224, 4294918144, v224
    ds_read_b128 v[180:183], v212 offset:512
    ds_read_b128 v[184:187], v212 offset:12800
    ds_read_b128 v[188:191], v212 offset:25088
    ds_read_b128 v[192:195], v212 offset:37376
    s_waitcnt lgkmcnt(0)
    v_mfma_f32_16x16x32_bf16 v[144:147], v[96:99], v[180:183], v[144:147]
    v_mfma_f32_16x16x32_bf16 v[148:151], v[100:103], v[180:183], v[148:151]
    v_mfma_f32_16x16x32_bf16 v[152:155], v[104:107], v[180:183], v[152:155]
    v_mfma_f32_16x16x32_bf16 v[156:159], v[96:99], v[184:187], v[156:159]
    v_mfma_f32_16x16x32_bf16 v[160:163], v[100:103], v[184:187], v[160:163]
    v_mfma_f32_16x16x32_bf16 v[164:167], v[104:107], v[184:187], v[164:167]
    v_mfma_f32_16x16x32_bf16 v[196:199], v[96:99], v[188:191], v[196:199]
    v_mfma_f32_16x16x32_bf16 v[200:203], v[100:103], v[188:191], v[200:203]
    v_mfma_f32_16x16x32_bf16 v[204:207], v[104:107], v[188:191], v[204:207]
    v_mfma_f32_16x16x32_bf16 v[208:211], v[96:99], v[192:195], v[208:211]
    v_mfma_f32_16x16x32_bf16 v[226:229], v[100:103], v[192:195], v[226:229]
    v_mfma_f32_16x16x32_bf16 v[230:233], v[104:107], v[192:195], v[230:233]
    s_waitcnt vmcnt(6)
    s_barrier
    s_mov_b32 s33, 270336
    s_add_u32 m0, s32, 122880
    s_nop 0
    buffer_load_dwordx4 v216, s[16:19], s33 offen lds
    s_add_u32 m0, s32, 123904
    s_nop 0
    buffer_load_dwordx4 v217, s[16:19], s33 offen lds
    s_add_u32 m0, s32, 124928
    s_nop 0
    buffer_load_dwordx4 v218, s[16:19], s33 offen lds
    s_add_u32 m0, s32, 125952
    s_nop 0
    buffer_load_dwordx4 v219, s[16:19], s33 offen lds
    s_add_u32 m0, s32, 126976
    s_nop 0
    buffer_load_dwordx4 v220, s[16:19], s33 offen lds
    s_add_u32 m0, s32, 128000
    s_nop 0
    buffer_load_dwordx4 v221, s[16:19], s33 offen lds
    ds_read_b64_tr_b16 v[108:109], v222 offset:0
    ds_read_b64_tr_b16 v[110:111], v222 offset:3072
    ds_read_b64_tr_b16 v[112:113], v223 offset:0
    ds_read_b64_tr_b16 v[114:115], v223 offset:3072
    ds_read_b64_tr_b16 v[116:117], v224 offset:0
    ds_read_b64_tr_b16 v[118:119], v224 offset:3072
    v_add_u32 v222, 24576, v222
    v_add_u32 v223, 24576, v223
    v_add_u32 v224, 24576, v224
    ds_read_b128 v[180:183], v213 offset:512
    ds_read_b128 v[184:187], v213 offset:12800
    ds_read_b128 v[188:191], v213 offset:25088
    ds_read_b128 v[192:195], v213 offset:37376
    s_waitcnt lgkmcnt(0)
    v_mfma_f32_16x16x32_bf16 v[144:147], v[108:111], v[180:183], v[144:147]
    v_mfma_f32_16x16x32_bf16 v[148:151], v[112:115], v[180:183], v[148:151]
    v_mfma_f32_16x16x32_bf16 v[152:155], v[116:119], v[180:183], v[152:155]
    v_mfma_f32_16x16x32_bf16 v[156:159], v[108:111], v[184:187], v[156:159]
    v_mfma_f32_16x16x32_bf16 v[160:163], v[112:115], v[184:187], v[160:163]
    v_mfma_f32_16x16x32_bf16 v[164:167], v[116:119], v[184:187], v[164:167]
    v_mfma_f32_16x16x32_bf16 v[196:199], v[108:111], v[188:191], v[196:199]
    v_mfma_f32_16x16x32_bf16 v[200:203], v[112:115], v[188:191], v[200:203]
    v_mfma_f32_16x16x32_bf16 v[204:207], v[116:119], v[188:191], v[204:207]
    v_mfma_f32_16x16x32_bf16 v[208:211], v[108:111], v[192:195], v[208:211]
    v_mfma_f32_16x16x32_bf16 v[226:229], v[112:115], v[192:195], v[226:229]
    v_mfma_f32_16x16x32_bf16 v[230:233], v[116:119], v[192:195], v[230:233]
    s_waitcnt vmcnt(6)
    s_barrier
    ds_read_b64_tr_b16 v[120:121], v222 offset:0
    ds_read_b64_tr_b16 v[122:123], v222 offset:3072
    ds_read_b64_tr_b16 v[124:125], v223 offset:0
    ds_read_b64_tr_b16 v[126:127], v223 offset:3072
    ds_read_b64_tr_b16 v[128:129], v224 offset:0
    ds_read_b64_tr_b16 v[130:131], v224 offset:3072
    v_add_u32 v222, 24576, v222
    v_add_u32 v223, 24576, v223
    v_add_u32 v224, 24576, v224
    ds_read_b128 v[180:183], v214 offset:512
    ds_read_b128 v[184:187], v214 offset:12800
    ds_read_b128 v[188:191], v214 offset:25088
    ds_read_b128 v[192:195], v214 offset:37376
    s_waitcnt lgkmcnt(0)
    v_mfma_f32_16x16x32_bf16 v[144:147], v[120:123], v[180:183], v[144:147]
    v_mfma_f32_16x16x32_bf16 v[148:151], v[124:127], v[180:183], v[148:151]
    v_mfma_f32_16x16x32_bf16 v[152:155], v[128:131], v[180:183], v[152:155]
    v_mfma_f32_16x16x32_bf16 v[156:159], v[120:123], v[184:187], v[156:159]
    v_mfma_f32_16x16x32_bf16 v[160:163], v[124:127], v[184:187], v[160:163]
    v_mfma_f32_16x16x32_bf16 v[164:167], v[128:131], v[184:187], v[164:167]
    v_mfma_f32_16x16x32_bf16 v[196:199], v[120:123], v[188:191], v[196:199]
    v_mfma_f32_16x16x32_bf16 v[200:203], v[124:127], v[188:191], v[200:203]
    v_mfma_f32_16x16x32_bf16 v[204:207], v[128:131], v[188:191], v[204:207]
    v_mfma_f32_16x16x32_bf16 v[208:211], v[120:123], v[192:195], v[208:211]
    v_mfma_f32_16x16x32_bf16 v[226:229], v[124:127], v[192:195], v[226:229]
    v_mfma_f32_16x16x32_bf16 v[230:233], v[128:131], v[192:195], v[230:233]
    s_waitcnt vmcnt(0)
    s_barrier
    ds_read_b64_tr_b16 v[132:133], v222 offset:0
    ds_read_b64_tr_b16 v[134:135], v222 offset:3072
    ds_read_b64_tr_b16 v[136:137], v223 offset:0
    ds_read_b64_tr_b16 v[138:139], v223 offset:3072
    ds_read_b64_tr_b16 v[140:141], v224 offset:0
    ds_read_b64_tr_b16 v[142:143], v224 offset:3072
    v_add_u32 v222, 4294918144, v222
    v_add_u32 v223, 4294918144, v223
    v_add_u32 v224, 4294918144, v224
    ds_read_b128 v[180:183], v215 offset:512
    ds_read_b128 v[184:187], v215 offset:12800
    ds_read_b128 v[188:191], v215 offset:25088
    ds_read_b128 v[192:195], v215 offset:37376
    s_waitcnt lgkmcnt(0)
    v_mfma_f32_16x16x32_bf16 v[144:147], v[132:135], v[180:183], v[144:147]
    v_mfma_f32_16x16x32_bf16 v[148:151], v[136:139], v[180:183], v[148:151]
    v_mfma_f32_16x16x32_bf16 v[152:155], v[140:143], v[180:183], v[152:155]
    v_mfma_f32_16x16x32_bf16 v[156:159], v[132:135], v[184:187], v[156:159]
    v_mfma_f32_16x16x32_bf16 v[160:163], v[136:139], v[184:187], v[160:163]
    v_mfma_f32_16x16x32_bf16 v[164:167], v[140:143], v[184:187], v[164:167]
    v_mfma_f32_16x16x32_bf16 v[196:199], v[132:135], v[188:191], v[196:199]
    v_mfma_f32_16x16x32_bf16 v[200:203], v[136:139], v[188:191], v[200:203]
    v_mfma_f32_16x16x32_bf16 v[204:207], v[140:143], v[188:191], v[204:207]
    v_mfma_f32_16x16x32_bf16 v[208:211], v[132:135], v[192:195], v[208:211]
    v_mfma_f32_16x16x32_bf16 v[226:229], v[136:139], v[192:195], v[226:229]
    v_mfma_f32_16x16x32_bf16 v[230:233], v[140:143], v[192:195], v[230:233]
    s_nop 7
    s_add_u32 s34, s29, 24576
    s_add_u32 s35, s34, 12288
    v_cvt_pk_bf16_f32 v180, v196, v197
    v_cvt_pk_bf16_f32 v181, v198, v199
    v_cvt_pk_bf16_f32 v182, v200, v201
    v_cvt_pk_bf16_f32 v183, v202, v203
    v_cvt_pk_bf16_f32 v184, v204, v205
    v_cvt_pk_bf16_f32 v185, v206, v207
    buffer_store_dwordx4 v[180:183], v225, s[24:27], s34 offen
    buffer_store_dwordx2 v[184:185], v225, s[24:27], s34 offen offset:16
    v_cvt_pk_bf16_f32 v186, v208, v209
    v_cvt_pk_bf16_f32 v187, v210, v211
    v_cvt_pk_bf16_f32 v188, v226, v227
    v_cvt_pk_bf16_f32 v189, v228, v229
    v_cvt_pk_bf16_f32 v190, v230, v231
    v_cvt_pk_bf16_f32 v191, v232, v233
    buffer_store_dwordx4 v[186:189], v225, s[24:27], s35 offen
    buffer_store_dwordx2 v[190:191], v225, s[24:27], s35 offen offset:16
    s_nop 1
    s_add_u32 s34, s29, 0
    s_add_u32 s35, s34, 12288
    v_cvt_pk_bf16_f32 v180, v144, v145
    v_cvt_pk_bf16_f32 v181, v146, v147
    v_cvt_pk_bf16_f32 v182, v148, v149
    v_cvt_pk_bf16_f32 v183, v150, v151
    v_cvt_pk_bf16_f32 v184, v152, v153
    v_cvt_pk_bf16_f32 v185, v154, v155
    buffer_store_dwordx4 v[180:183], v225, s[24:27], s34 offen
    buffer_store_dwordx2 v[184:185], v225, s[24:27], s34 offen offset:16
    v_cvt_pk_bf16_f32 v186, v156, v157
    v_cvt_pk_bf16_f32 v187, v158, v159
    v_cvt_pk_bf16_f32 v188, v160, v161
    v_cvt_pk_bf16_f32 v189, v162, v163
    v_cvt_pk_bf16_f32 v190, v164, v165
    v_cvt_pk_bf16_f32 v191, v166, v167
    buffer_store_dwordx4 v[186:189], v225, s[24:27], s35 offen
    buffer_store_dwordx2 v[190:191], v225, s[24:27], s35 offen offset:16
    v_add_u32 v212, 49152, v212
    v_add_u32 v213, 49152, v213
    v_add_u32 v214, 49152, v214
    v_add_u32 v215, 49152, v215
    s_barrier
    ds_read_b128 v[180:183], v212 offset:0
    ds_read_b128 v[184:187], v212 offset:12288
    ds_read_b128 v[188:191], v213 offset:0
    ds_read_b128 v[192:195], v213 offset:12288
    ds_read_b128 v[196:199], v214 offset:0
    ds_read_b128 v[200:203], v214 offset:12288
    ds_read_b128 v[204:207], v215 offset:0
    ds_read_b128 v[208:211], v215 offset:12288
    s_waitcnt lgkmcnt(6)
    v_mfma_f32_16x16x32_bf16 v[144:147], v[0:3], v[180:183], v[168:171]
    v_mfma_f32_16x16x32_bf16 v[148:151], v[4:7], v[180:183], v[172:175]
    v_mfma_f32_16x16x32_bf16 v[152:155], v[8:11], v[180:183], v[176:179]
    v_mfma_f32_16x16x32_bf16 v[156:159], v[0:3], v[184:187], v[168:171]
    v_mfma_f32_16x16x32_bf16 v[160:163], v[4:7], v[184:187], v[172:175]
    v_mfma_f32_16x16x32_bf16 v[164:167], v[8:11], v[184:187], v[176:179]
    ds_read_b128 v[180:183], v212 offset:256
    ds_read_b128 v[184:187], v212 offset:12544
    s_waitcnt lgkmcnt(6)
    v_mfma_f32_16x16x32_bf16 v[144:147], v[12:15], v[188:191], v[144:147]
    v_mfma_f32_16x16x32_bf16 v[148:151], v[16:19], v[188:191], v[148:151]
    v_mfma_f32_16x16x32_bf16 v[152:155], v[20:23], v[188:191], v[152:155]
    v_mfma_f32_16x16x32_bf16 v[156:159], v[12:15], v[192:195], v[156:159]
    v_mfma_f32_16x16x32_bf16 v[160:163], v[16:19], v[192:195], v[160:163]
    v_mfma_f32_16x16x32_bf16 v[164:167], v[20:23], v[192:195], v[164:167]
    ds_read_b128 v[188:191], v213 offset:256
    ds_read_b128 v[192:195], v213 offset:12544
    s_waitcnt lgkmcnt(6)
    v_mfma_f32_16x16x32_bf16 v[144:147], v[24:27], v[196:199], v[144:147]
    v_mfma_f32_16x16x32_bf16 v[148:151], v[28:31], v[196:199], v[148:151]
    v_mfma_f32_16x16x32_bf16 v[152:155], v[32:35], v[196:199], v[152:155]
    v_mfma_f32_16x16x32_bf16 v[156:159], v[24:27], v[200:203], v[156:159]
    v_mfma_f32_16x16x32_bf16 v[160:163], v[28:31], v[200:203], v[160:163]
    v_mfma_f32_16x16x32_bf16 v[164:167], v[32:35], v[200:203], v[164:167]
    ds_read_b128 v[196:199], v214 offset:256
    ds_read_b128 v[200:203], v214 offset:12544
    s_waitcnt lgkmcnt(6)
    v_mfma_f32_16x16x32_bf16 v[144:147], v[36:39], v[204:207], v[144:147]
    v_mfma_f32_16x16x32_bf16 v[148:151], v[40:43], v[204:207], v[148:151]
    v_mfma_f32_16x16x32_bf16 v[152:155], v[44:47], v[204:207], v[152:155]
    v_mfma_f32_16x16x32_bf16 v[156:159], v[36:39], v[208:211], v[156:159]
    v_mfma_f32_16x16x32_bf16 v[160:163], v[40:43], v[208:211], v[160:163]
    v_mfma_f32_16x16x32_bf16 v[164:167], v[44:47], v[208:211], v[164:167]
    ds_read_b128 v[204:207], v215 offset:256
    ds_read_b128 v[208:211], v215 offset:12544
    s_waitcnt lgkmcnt(6)
    v_mfma_f32_16x16x32_bf16 v[144:147], v[48:51], v[180:183], v[144:147]
    v_mfma_f32_16x16x32_bf16 v[148:151], v[52:55], v[180:183], v[148:151]
    v_mfma_f32_16x16x32_bf16 v[152:155], v[56:59], v[180:183], v[152:155]
    v_mfma_f32_16x16x32_bf16 v[156:159], v[48:51], v[184:187], v[156:159]
    v_mfma_f32_16x16x32_bf16 v[160:163], v[52:55], v[184:187], v[160:163]
    v_mfma_f32_16x16x32_bf16 v[164:167], v[56:59], v[184:187], v[164:167]
    ds_read_b128 v[180:183], v212 offset:512
    ds_read_b128 v[184:187], v212 offset:12800
    s_waitcnt lgkmcnt(6)
    v_mfma_f32_16x16x32_bf16 v[144:147], v[60:63], v[188:191], v[144:147]
    v_mfma_f32_16x16x32_bf16 v[148:151], v[64:67], v[188:191], v[148:151]
    v_mfma_f32_16x16x32_bf16 v[152:155], v[68:71], v[188:191], v[152:155]
    v_mfma_f32_16x16x32_bf16 v[156:159], v[60:63], v[192:195], v[156:159]
    v_mfma_f32_16x16x32_bf16 v[160:163], v[64:67], v[192:195], v[160:163]
    v_mfma_f32_16x16x32_bf16 v[164:167], v[68:71], v[192:195], v[164:167]
    ds_read_b128 v[188:191], v213 offset:512
    ds_read_b128 v[192:195], v213 offset:12800
    s_waitcnt lgkmcnt(6)
    v_mfma_f32_16x16x32_bf16 v[144:147], v[72:75], v[196:199], v[144:147]
    v_mfma_f32_16x16x32_bf16 v[148:151], v[76:79], v[196:199], v[148:151]
    v_mfma_f32_16x16x32_bf16 v[152:155], v[80:83], v[196:199], v[152:155]
    v_mfma_f32_16x16x32_bf16 v[156:159], v[72:75], v[200:203], v[156:159]
    v_mfma_f32_16x16x32_bf16 v[160:163], v[76:79], v[200:203], v[160:163]
    v_mfma_f32_16x16x32_bf16 v[164:167], v[80:83], v[200:203], v[164:167]
    ds_read_b128 v[196:199], v214 offset:512
    ds_read_b128 v[200:203], v214 offset:12800
    s_waitcnt lgkmcnt(6)
    v_mfma_f32_16x16x32_bf16 v[144:147], v[84:87], v[204:207], v[144:147]
    v_mfma_f32_16x16x32_bf16 v[148:151], v[88:91], v[204:207], v[148:151]
    v_mfma_f32_16x16x32_bf16 v[152:155], v[92:95], v[204:207], v[152:155]
    v_mfma_f32_16x16x32_bf16 v[156:159], v[84:87], v[208:211], v[156:159]
    v_mfma_f32_16x16x32_bf16 v[160:163], v[88:91], v[208:211], v[160:163]
    v_mfma_f32_16x16x32_bf16 v[164:167], v[92:95], v[208:211], v[164:167]
    ds_read_b128 v[204:207], v215 offset:512
    ds_read_b128 v[208:211], v215 offset:12800
    s_waitcnt lgkmcnt(6)
    v_mfma_f32_16x16x32_bf16 v[144:147], v[96:99], v[180:183], v[144:147]
    v_mfma_f32_16x16x32_bf16 v[148:151], v[100:103], v[180:183], v[148:151]
    v_mfma_f32_16x16x32_bf16 v[152:155], v[104:107], v[180:183], v[152:155]
    v_mfma_f32_16x16x32_bf16 v[156:159], v[96:99], v[184:187], v[156:159]
    v_mfma_f32_16x16x32_bf16 v[160:163], v[100:103], v[184:187], v[160:163]
    v_mfma_f32_16x16x32_bf16 v[164:167], v[104:107], v[184:187], v[164:167]
    s_waitcnt lgkmcnt(4)
    v_mfma_f32_16x16x32_bf16 v[144:147], v[108:111], v[188:191], v[144:147]
    v_mfma_f32_16x16x32_bf16 v[148:151], v[112:115], v[188:191], v[148:151]
    v_mfma_f32_16x16x32_bf16 v[152:155], v[116:119], v[188:191], v[152:155]
    v_mfma_f32_16x16x32_bf16 v[156:159], v[108:111], v[192:195], v[156:159]
    v_mfma_f32_16x16x32_bf16 v[160:163], v[112:115], v[192:195], v[160:163]
    v_mfma_f32_16x16x32_bf16 v[164:167], v[116:119], v[192:195], v[164:167]
    s_waitcnt lgkmcnt(2)
    v_mfma_f32_16x16x32_bf16 v[144:147], v[120:123], v[196:199], v[144:147]
    v_mfma_f32_16x16x32_bf16 v[148:151], v[124:127], v[196:199], v[148:151]
    v_mfma_f32_16x16x32_bf16 v[152:155], v[128:131], v[196:199], v[152:155]
    v_mfma_f32_16x16x32_bf16 v[156:159], v[120:123], v[200:203], v[156:159]
    v_mfma_f32_16x16x32_bf16 v[160:163], v[124:127], v[200:203], v[160:163]
    v_mfma_f32_16x16x32_bf16 v[164:167], v[128:131], v[200:203], v[164:167]
    s_waitcnt lgkmcnt(0)
    v_mfma_f32_16x16x32_bf16 v[144:147], v[132:135], v[204:207], v[144:147]
    v_mfma_f32_16x16x32_bf16 v[148:151], v[136:139], v[204:207], v[148:151]
    v_mfma_f32_16x16x32_bf16 v[152:155], v[140:143], v[204:207], v[152:155]
    v_mfma_f32_16x16x32_bf16 v[156:159], v[132:135], v[208:211], v[156:159]
    v_mfma_f32_16x16x32_bf16 v[160:163], v[136:139], v[208:211], v[160:163]
    v_mfma_f32_16x16x32_bf16 v[164:167], v[140:143], v[208:211], v[164:167]
    v_add_u32 v212, 24576, v212
    v_add_u32 v213, 24576, v213
    v_add_u32 v214, 24576, v214
    v_add_u32 v215, 24576, v215
    s_barrier
    ds_read_b128 v[180:183], v212 offset:0
    ds_read_b128 v[184:187], v212 offset:12288
    ds_read_b128 v[188:191], v213 offset:0
    ds_read_b128 v[192:195], v213 offset:12288
    ds_read_b128 v[196:199], v214 offset:0
    ds_read_b128 v[200:203], v214 offset:12288
    ds_read_b128 v[204:207], v215 offset:0
    ds_read_b128 v[208:211], v215 offset:12288
    s_add_u32 s34, s29, 49152
    s_add_u32 s35, s34, 12288
    v_cvt_pk_bf16_f32 v226, v144, v145
    v_cvt_pk_bf16_f32 v227, v146, v147
    v_cvt_pk_bf16_f32 v228, v148, v149
    v_cvt_pk_bf16_f32 v229, v150, v151
    v_cvt_pk_bf16_f32 v230, v152, v153
    v_cvt_pk_bf16_f32 v231, v154, v155
    buffer_store_dwordx4 v[226:229], v225, s[24:27], s34 offen
    buffer_store_dwordx2 v[230:231], v225, s[24:27], s34 offen offset:16
    v_cvt_pk_bf16_f32 v232, v156, v157
    v_cvt_pk_bf16_f32 v233, v158, v159
    v_cvt_pk_bf16_f32 v234, v160, v161
    v_cvt_pk_bf16_f32 v235, v162, v163
    v_cvt_pk_bf16_f32 v236, v164, v165
    v_cvt_pk_bf16_f32 v237, v166, v167
    buffer_store_dwordx4 v[232:235], v225, s[24:27], s35 offen
    buffer_store_dwordx2 v[236:237], v225, s[24:27], s35 offen offset:16
    s_waitcnt lgkmcnt(6)
    v_mfma_f32_16x16x32_bf16 v[144:147], v[0:3], v[180:183], v[168:171]
    v_mfma_f32_16x16x32_bf16 v[148:151], v[4:7], v[180:183], v[172:175]
    v_mfma_f32_16x16x32_bf16 v[152:155], v[8:11], v[180:183], v[176:179]
    v_mfma_f32_16x16x32_bf16 v[156:159], v[0:3], v[184:187], v[168:171]
    v_mfma_f32_16x16x32_bf16 v[160:163], v[4:7], v[184:187], v[172:175]
    v_mfma_f32_16x16x32_bf16 v[164:167], v[8:11], v[184:187], v[176:179]
    ds_read_b128 v[180:183], v212 offset:256
    ds_read_b128 v[184:187], v212 offset:12544
    s_waitcnt lgkmcnt(6)
    v_mfma_f32_16x16x32_bf16 v[144:147], v[12:15], v[188:191], v[144:147]
    v_mfma_f32_16x16x32_bf16 v[148:151], v[16:19], v[188:191], v[148:151]
    v_mfma_f32_16x16x32_bf16 v[152:155], v[20:23], v[188:191], v[152:155]
    v_mfma_f32_16x16x32_bf16 v[156:159], v[12:15], v[192:195], v[156:159]
    v_mfma_f32_16x16x32_bf16 v[160:163], v[16:19], v[192:195], v[160:163]
    v_mfma_f32_16x16x32_bf16 v[164:167], v[20:23], v[192:195], v[164:167]
    ds_read_b128 v[188:191], v213 offset:256
    ds_read_b128 v[192:195], v213 offset:12544
    s_waitcnt lgkmcnt(6)
    v_mfma_f32_16x16x32_bf16 v[144:147], v[24:27], v[196:199], v[144:147]
    v_mfma_f32_16x16x32_bf16 v[148:151], v[28:31], v[196:199], v[148:151]
    v_mfma_f32_16x16x32_bf16 v[152:155], v[32:35], v[196:199], v[152:155]
    v_mfma_f32_16x16x32_bf16 v[156:159], v[24:27], v[200:203], v[156:159]
    v_mfma_f32_16x16x32_bf16 v[160:163], v[28:31], v[200:203], v[160:163]
    v_mfma_f32_16x16x32_bf16 v[164:167], v[32:35], v[200:203], v[164:167]
    ds_read_b128 v[196:199], v214 offset:256
    ds_read_b128 v[200:203], v214 offset:12544
    s_waitcnt lgkmcnt(6)
    v_mfma_f32_16x16x32_bf16 v[144:147], v[36:39], v[204:207], v[144:147]
    v_mfma_f32_16x16x32_bf16 v[148:151], v[40:43], v[204:207], v[148:151]
    v_mfma_f32_16x16x32_bf16 v[152:155], v[44:47], v[204:207], v[152:155]
    v_mfma_f32_16x16x32_bf16 v[156:159], v[36:39], v[208:211], v[156:159]
    v_mfma_f32_16x16x32_bf16 v[160:163], v[40:43], v[208:211], v[160:163]
    v_mfma_f32_16x16x32_bf16 v[164:167], v[44:47], v[208:211], v[164:167]
    ds_read_b128 v[204:207], v215 offset:256
    ds_read_b128 v[208:211], v215 offset:12544
    s_waitcnt lgkmcnt(6)
    v_mfma_f32_16x16x32_bf16 v[144:147], v[48:51], v[180:183], v[144:147]
    v_mfma_f32_16x16x32_bf16 v[148:151], v[52:55], v[180:183], v[148:151]
    v_mfma_f32_16x16x32_bf16 v[152:155], v[56:59], v[180:183], v[152:155]
    v_mfma_f32_16x16x32_bf16 v[156:159], v[48:51], v[184:187], v[156:159]
    v_mfma_f32_16x16x32_bf16 v[160:163], v[52:55], v[184:187], v[160:163]
    v_mfma_f32_16x16x32_bf16 v[164:167], v[56:59], v[184:187], v[164:167]
    ds_read_b128 v[180:183], v212 offset:512
    ds_read_b128 v[184:187], v212 offset:12800
    s_waitcnt lgkmcnt(6)
    v_mfma_f32_16x16x32_bf16 v[144:147], v[60:63], v[188:191], v[144:147]
    v_mfma_f32_16x16x32_bf16 v[148:151], v[64:67], v[188:191], v[148:151]
    v_mfma_f32_16x16x32_bf16 v[152:155], v[68:71], v[188:191], v[152:155]
    v_mfma_f32_16x16x32_bf16 v[156:159], v[60:63], v[192:195], v[156:159]
    v_mfma_f32_16x16x32_bf16 v[160:163], v[64:67], v[192:195], v[160:163]
    v_mfma_f32_16x16x32_bf16 v[164:167], v[68:71], v[192:195], v[164:167]
    ds_read_b128 v[188:191], v213 offset:512
    ds_read_b128 v[192:195], v213 offset:12800
    s_waitcnt lgkmcnt(6)
    v_mfma_f32_16x16x32_bf16 v[144:147], v[72:75], v[196:199], v[144:147]
    v_mfma_f32_16x16x32_bf16 v[148:151], v[76:79], v[196:199], v[148:151]
    v_mfma_f32_16x16x32_bf16 v[152:155], v[80:83], v[196:199], v[152:155]
    v_mfma_f32_16x16x32_bf16 v[156:159], v[72:75], v[200:203], v[156:159]
    v_mfma_f32_16x16x32_bf16 v[160:163], v[76:79], v[200:203], v[160:163]
    v_mfma_f32_16x16x32_bf16 v[164:167], v[80:83], v[200:203], v[164:167]
    ds_read_b128 v[196:199], v214 offset:512
    ds_read_b128 v[200:203], v214 offset:12800
    s_waitcnt lgkmcnt(6)
    v_mfma_f32_16x16x32_bf16 v[144:147], v[84:87], v[204:207], v[144:147]
    v_mfma_f32_16x16x32_bf16 v[148:151], v[88:91], v[204:207], v[148:151]
    v_mfma_f32_16x16x32_bf16 v[152:155], v[92:95], v[204:207], v[152:155]
    v_mfma_f32_16x16x32_bf16 v[156:159], v[84:87], v[208:211], v[156:159]
    v_mfma_f32_16x16x32_bf16 v[160:163], v[88:91], v[208:211], v[160:163]
    v_mfma_f32_16x16x32_bf16 v[164:167], v[92:95], v[208:211], v[164:167]
    ds_read_b128 v[204:207], v215 offset:512
    ds_read_b128 v[208:211], v215 offset:12800
    s_waitcnt lgkmcnt(6)
    v_mfma_f32_16x16x32_bf16 v[144:147], v[96:99], v[180:183], v[144:147]
    v_mfma_f32_16x16x32_bf16 v[148:151], v[100:103], v[180:183], v[148:151]
    v_mfma_f32_16x16x32_bf16 v[152:155], v[104:107], v[180:183], v[152:155]
    v_mfma_f32_16x16x32_bf16 v[156:159], v[96:99], v[184:187], v[156:159]
    v_mfma_f32_16x16x32_bf16 v[160:163], v[100:103], v[184:187], v[160:163]
    v_mfma_f32_16x16x32_bf16 v[164:167], v[104:107], v[184:187], v[164:167]
    s_waitcnt lgkmcnt(4)
    v_mfma_f32_16x16x32_bf16 v[144:147], v[108:111], v[188:191], v[144:147]
    v_mfma_f32_16x16x32_bf16 v[148:151], v[112:115], v[188:191], v[148:151]
    v_mfma_f32_16x16x32_bf16 v[152:155], v[116:119], v[188:191], v[152:155]
    v_mfma_f32_16x16x32_bf16 v[156:159], v[108:111], v[192:195], v[156:159]
    v_mfma_f32_16x16x32_bf16 v[160:163], v[112:115], v[192:195], v[160:163]
    v_mfma_f32_16x16x32_bf16 v[164:167], v[116:119], v[192:195], v[164:167]
    s_waitcnt lgkmcnt(2)
    v_mfma_f32_16x16x32_bf16 v[144:147], v[120:123], v[196:199], v[144:147]
    v_mfma_f32_16x16x32_bf16 v[148:151], v[124:127], v[196:199], v[148:151]
    v_mfma_f32_16x16x32_bf16 v[152:155], v[128:131], v[196:199], v[152:155]
    v_mfma_f32_16x16x32_bf16 v[156:159], v[120:123], v[200:203], v[156:159]
    v_mfma_f32_16x16x32_bf16 v[160:163], v[124:127], v[200:203], v[160:163]
    v_mfma_f32_16x16x32_bf16 v[164:167], v[128:131], v[200:203], v[164:167]
    s_waitcnt lgkmcnt(0)
    v_mfma_f32_16x16x32_bf16 v[144:147], v[132:135], v[204:207], v[144:147]
    v_mfma_f32_16x16x32_bf16 v[148:151], v[136:139], v[204:207], v[148:151]
    v_mfma_f32_16x16x32_bf16 v[152:155], v[140:143], v[204:207], v[152:155]
    v_mfma_f32_16x16x32_bf16 v[156:159], v[132:135], v[208:211], v[156:159]
    v_mfma_f32_16x16x32_bf16 v[160:163], v[136:139], v[208:211], v[160:163]
    v_mfma_f32_16x16x32_bf16 v[164:167], v[140:143], v[208:211], v[164:167]
    v_add_u32 v212, 24576, v212
    v_add_u32 v213, 24576, v213
    v_add_u32 v214, 24576, v214
    v_add_u32 v215, 24576, v215
    s_barrier
    ds_read_b128 v[180:183], v212 offset:0
    ds_read_b128 v[184:187], v212 offset:12288
    ds_read_b128 v[188:191], v213 offset:0
    ds_read_b128 v[192:195], v213 offset:12288
    ds_read_b128 v[196:199], v214 offset:0
    ds_read_b128 v[200:203], v214 offset:12288
    ds_read_b128 v[204:207], v215 offset:0
    ds_read_b128 v[208:211], v215 offset:12288
    s_add_u32 s34, s29, 73728
    s_add_u32 s35, s34, 12288
    v_cvt_pk_bf16_f32 v226, v144, v145
    v_cvt_pk_bf16_f32 v227, v146, v147
    v_cvt_pk_bf16_f32 v228, v148, v149
    v_cvt_pk_bf16_f32 v229, v150, v151
    v_cvt_pk_bf16_f32 v230, v152, v153
    v_cvt_pk_bf16_f32 v231, v154, v155
    buffer_store_dwordx4 v[226:229], v225, s[24:27], s34 offen
    buffer_store_dwordx2 v[230:231], v225, s[24:27], s34 offen offset:16
    v_cvt_pk_bf16_f32 v232, v156, v157
    v_cvt_pk_bf16_f32 v233, v158, v159
    v_cvt_pk_bf16_f32 v234, v160, v161
    v_cvt_pk_bf16_f32 v235, v162, v163
    v_cvt_pk_bf16_f32 v236, v164, v165
    v_cvt_pk_bf16_f32 v237, v166, v167
    buffer_store_dwordx4 v[232:235], v225, s[24:27], s35 offen
    buffer_store_dwordx2 v[236:237], v225, s[24:27], s35 offen offset:16
    s_waitcnt lgkmcnt(6)
    v_mfma_f32_16x16x32_bf16 v[144:147], v[0:3], v[180:183], v[168:171]
    v_mfma_f32_16x16x32_bf16 v[148:151], v[4:7], v[180:183], v[172:175]
    v_mfma_f32_16x16x32_bf16 v[152:155], v[8:11], v[180:183], v[176:179]
    v_mfma_f32_16x16x32_bf16 v[156:159], v[0:3], v[184:187], v[168:171]
    v_mfma_f32_16x16x32_bf16 v[160:163], v[4:7], v[184:187], v[172:175]
    v_mfma_f32_16x16x32_bf16 v[164:167], v[8:11], v[184:187], v[176:179]
    ds_read_b128 v[180:183], v212 offset:256
    ds_read_b128 v[184:187], v212 offset:12544
    s_waitcnt lgkmcnt(6)
    v_mfma_f32_16x16x32_bf16 v[144:147], v[12:15], v[188:191], v[144:147]
    v_mfma_f32_16x16x32_bf16 v[148:151], v[16:19], v[188:191], v[148:151]
    v_mfma_f32_16x16x32_bf16 v[152:155], v[20:23], v[188:191], v[152:155]
    v_mfma_f32_16x16x32_bf16 v[156:159], v[12:15], v[192:195], v[156:159]
    v_mfma_f32_16x16x32_bf16 v[160:163], v[16:19], v[192:195], v[160:163]
    v_mfma_f32_16x16x32_bf16 v[164:167], v[20:23], v[192:195], v[164:167]
    ds_read_b128 v[188:191], v213 offset:256
    ds_read_b128 v[192:195], v213 offset:12544
    s_waitcnt lgkmcnt(6)
    v_mfma_f32_16x16x32_bf16 v[144:147], v[24:27], v[196:199], v[144:147]
    v_mfma_f32_16x16x32_bf16 v[148:151], v[28:31], v[196:199], v[148:151]
    v_mfma_f32_16x16x32_bf16 v[152:155], v[32:35], v[196:199], v[152:155]
    v_mfma_f32_16x16x32_bf16 v[156:159], v[24:27], v[200:203], v[156:159]
    v_mfma_f32_16x16x32_bf16 v[160:163], v[28:31], v[200:203], v[160:163]
    v_mfma_f32_16x16x32_bf16 v[164:167], v[32:35], v[200:203], v[164:167]
    ds_read_b128 v[196:199], v214 offset:256
    ds_read_b128 v[200:203], v214 offset:12544
    s_waitcnt lgkmcnt(6)
    v_mfma_f32_16x16x32_bf16 v[144:147], v[36:39], v[204:207], v[144:147]
    v_mfma_f32_16x16x32_bf16 v[148:151], v[40:43], v[204:207], v[148:151]
    v_mfma_f32_16x16x32_bf16 v[152:155], v[44:47], v[204:207], v[152:155]
    v_mfma_f32_16x16x32_bf16 v[156:159], v[36:39], v[208:211], v[156:159]
    v_mfma_f32_16x16x32_bf16 v[160:163], v[40:43], v[208:211], v[160:163]
    v_mfma_f32_16x16x32_bf16 v[164:167], v[44:47], v[208:211], v[164:167]
    ds_read_b128 v[204:207], v215 offset:256
    ds_read_b128 v[208:211], v215 offset:12544
    s_waitcnt lgkmcnt(6)
    v_mfma_f32_16x16x32_bf16 v[144:147], v[48:51], v[180:183], v[144:147]
    v_mfma_f32_16x16x32_bf16 v[148:151], v[52:55], v[180:183], v[148:151]
    v_mfma_f32_16x16x32_bf16 v[152:155], v[56:59], v[180:183], v[152:155]
    v_mfma_f32_16x16x32_bf16 v[156:159], v[48:51], v[184:187], v[156:159]
    v_mfma_f32_16x16x32_bf16 v[160:163], v[52:55], v[184:187], v[160:163]
    v_mfma_f32_16x16x32_bf16 v[164:167], v[56:59], v[184:187], v[164:167]
    ds_read_b128 v[180:183], v212 offset:512
    ds_read_b128 v[184:187], v212 offset:12800
    s_waitcnt lgkmcnt(6)
    v_mfma_f32_16x16x32_bf16 v[144:147], v[60:63], v[188:191], v[144:147]
    v_mfma_f32_16x16x32_bf16 v[148:151], v[64:67], v[188:191], v[148:151]
    v_mfma_f32_16x16x32_bf16 v[152:155], v[68:71], v[188:191], v[152:155]
    v_mfma_f32_16x16x32_bf16 v[156:159], v[60:63], v[192:195], v[156:159]
    v_mfma_f32_16x16x32_bf16 v[160:163], v[64:67], v[192:195], v[160:163]
    v_mfma_f32_16x16x32_bf16 v[164:167], v[68:71], v[192:195], v[164:167]
    ds_read_b128 v[188:191], v213 offset:512
    ds_read_b128 v[192:195], v213 offset:12800
    s_waitcnt lgkmcnt(6)
    v_mfma_f32_16x16x32_bf16 v[144:147], v[72:75], v[196:199], v[144:147]
    v_mfma_f32_16x16x32_bf16 v[148:151], v[76:79], v[196:199], v[148:151]
    v_mfma_f32_16x16x32_bf16 v[152:155], v[80:83], v[196:199], v[152:155]
    v_mfma_f32_16x16x32_bf16 v[156:159], v[72:75], v[200:203], v[156:159]
    v_mfma_f32_16x16x32_bf16 v[160:163], v[76:79], v[200:203], v[160:163]
    v_mfma_f32_16x16x32_bf16 v[164:167], v[80:83], v[200:203], v[164:167]
    ds_read_b128 v[196:199], v214 offset:512
    ds_read_b128 v[200:203], v214 offset:12800
    s_waitcnt lgkmcnt(6)
    v_mfma_f32_16x16x32_bf16 v[144:147], v[84:87], v[204:207], v[144:147]
    v_mfma_f32_16x16x32_bf16 v[148:151], v[88:91], v[204:207], v[148:151]
    v_mfma_f32_16x16x32_bf16 v[152:155], v[92:95], v[204:207], v[152:155]
    v_mfma_f32_16x16x32_bf16 v[156:159], v[84:87], v[208:211], v[156:159]
    v_mfma_f32_16x16x32_bf16 v[160:163], v[88:91], v[208:211], v[160:163]
    v_mfma_f32_16x16x32_bf16 v[164:167], v[92:95], v[208:211], v[164:167]
    ds_read_b128 v[204:207], v215 offset:512
    ds_read_b128 v[208:211], v215 offset:12800
    s_waitcnt lgkmcnt(6)
    v_mfma_f32_16x16x32_bf16 v[144:147], v[96:99], v[180:183], v[144:147]
    v_mfma_f32_16x16x32_bf16 v[148:151], v[100:103], v[180:183], v[148:151]
    v_mfma_f32_16x16x32_bf16 v[152:155], v[104:107], v[180:183], v[152:155]
    v_mfma_f32_16x16x32_bf16 v[156:159], v[96:99], v[184:187], v[156:159]
    v_mfma_f32_16x16x32_bf16 v[160:163], v[100:103], v[184:187], v[160:163]
    v_mfma_f32_16x16x32_bf16 v[164:167], v[104:107], v[184:187], v[164:167]
    s_waitcnt lgkmcnt(4)
    v_mfma_f32_16x16x32_bf16 v[144:147], v[108:111], v[188:191], v[144:147]
    v_mfma_f32_16x16x32_bf16 v[148:151], v[112:115], v[188:191], v[148:151]
    v_mfma_f32_16x16x32_bf16 v[152:155], v[116:119], v[188:191], v[152:155]
    v_mfma_f32_16x16x32_bf16 v[156:159], v[108:111], v[192:195], v[156:159]
    v_mfma_f32_16x16x32_bf16 v[160:163], v[112:115], v[192:195], v[160:163]
    v_mfma_f32_16x16x32_bf16 v[164:167], v[116:119], v[192:195], v[164:167]
    s_waitcnt lgkmcnt(2)
    v_mfma_f32_16x16x32_bf16 v[144:147], v[120:123], v[196:199], v[144:147]
    v_mfma_f32_16x16x32_bf16 v[148:151], v[124:127], v[196:199], v[148:151]
    v_mfma_f32_16x16x32_bf16 v[152:155], v[128:131], v[196:199], v[152:155]
    v_mfma_f32_16x16x32_bf16 v[156:159], v[120:123], v[200:203], v[156:159]
    v_mfma_f32_16x16x32_bf16 v[160:163], v[124:127], v[200:203], v[160:163]
    v_mfma_f32_16x16x32_bf16 v[164:167], v[128:131], v[200:203], v[164:167]
    s_waitcnt lgkmcnt(0)
    v_mfma_f32_16x16x32_bf16 v[144:147], v[132:135], v[204:207], v[144:147]
    v_mfma_f32_16x16x32_bf16 v[148:151], v[136:139], v[204:207], v[148:151]
    v_mfma_f32_16x16x32_bf16 v[152:155], v[140:143], v[204:207], v[152:155]
    v_mfma_f32_16x16x32_bf16 v[156:159], v[132:135], v[208:211], v[156:159]
    v_mfma_f32_16x16x32_bf16 v[160:163], v[136:139], v[208:211], v[160:163]
    v_mfma_f32_16x16x32_bf16 v[164:167], v[140:143], v[208:211], v[164:167]
    v_add_u32 v212, 24576, v212
    v_add_u32 v213, 24576, v213
    v_add_u32 v214, 24576, v214
    v_add_u32 v215, 24576, v215
    s_barrier
    ds_read_b128 v[180:183], v212 offset:0
    ds_read_b128 v[184:187], v212 offset:12288
    ds_read_b128 v[188:191], v213 offset:0
    ds_read_b128 v[192:195], v213 offset:12288
    ds_read_b128 v[196:199], v214 offset:0
    ds_read_b128 v[200:203], v214 offset:12288
    ds_read_b128 v[204:207], v215 offset:0
    ds_read_b128 v[208:211], v215 offset:12288
    s_add_u32 s34, s29, 98304
    s_add_u32 s35, s34, 12288
    v_cvt_pk_bf16_f32 v226, v144, v145
    v_cvt_pk_bf16_f32 v227, v146, v147
    v_cvt_pk_bf16_f32 v228, v148, v149
    v_cvt_pk_bf16_f32 v229, v150, v151
    v_cvt_pk_bf16_f32 v230, v152, v153
    v_cvt_pk_bf16_f32 v231, v154, v155
    buffer_store_dwordx4 v[226:229], v225, s[24:27], s34 offen
    buffer_store_dwordx2 v[230:231], v225, s[24:27], s34 offen offset:16
    v_cvt_pk_bf16_f32 v232, v156, v157
    v_cvt_pk_bf16_f32 v233, v158, v159
    v_cvt_pk_bf16_f32 v234, v160, v161
    v_cvt_pk_bf16_f32 v235, v162, v163
    v_cvt_pk_bf16_f32 v236, v164, v165
    v_cvt_pk_bf16_f32 v237, v166, v167
    buffer_store_dwordx4 v[232:235], v225, s[24:27], s35 offen
    buffer_store_dwordx2 v[236:237], v225, s[24:27], s35 offen offset:16
    s_waitcnt lgkmcnt(6)
    v_mfma_f32_16x16x32_bf16 v[144:147], v[0:3], v[180:183], v[168:171]
    v_mfma_f32_16x16x32_bf16 v[148:151], v[4:7], v[180:183], v[172:175]
    v_mfma_f32_16x16x32_bf16 v[152:155], v[8:11], v[180:183], v[176:179]
    v_mfma_f32_16x16x32_bf16 v[156:159], v[0:3], v[184:187], v[168:171]
    v_mfma_f32_16x16x32_bf16 v[160:163], v[4:7], v[184:187], v[172:175]
    v_mfma_f32_16x16x32_bf16 v[164:167], v[8:11], v[184:187], v[176:179]
    ds_read_b128 v[180:183], v212 offset:256
    ds_read_b128 v[184:187], v212 offset:12544
    s_waitcnt lgkmcnt(6)
    v_mfma_f32_16x16x32_bf16 v[144:147], v[12:15], v[188:191], v[144:147]
    v_mfma_f32_16x16x32_bf16 v[148:151], v[16:19], v[188:191], v[148:151]
    v_mfma_f32_16x16x32_bf16 v[152:155], v[20:23], v[188:191], v[152:155]
    v_mfma_f32_16x16x32_bf16 v[156:159], v[12:15], v[192:195], v[156:159]
    v_mfma_f32_16x16x32_bf16 v[160:163], v[16:19], v[192:195], v[160:163]
    v_mfma_f32_16x16x32_bf16 v[164:167], v[20:23], v[192:195], v[164:167]
    ds_read_b128 v[188:191], v213 offset:256
    ds_read_b128 v[192:195], v213 offset:12544
    s_waitcnt lgkmcnt(6)
    v_mfma_f32_16x16x32_bf16 v[144:147], v[24:27], v[196:199], v[144:147]
    v_mfma_f32_16x16x32_bf16 v[148:151], v[28:31], v[196:199], v[148:151]
    v_mfma_f32_16x16x32_bf16 v[152:155], v[32:35], v[196:199], v[152:155]
    v_mfma_f32_16x16x32_bf16 v[156:159], v[24:27], v[200:203], v[156:159]
    v_mfma_f32_16x16x32_bf16 v[160:163], v[28:31], v[200:203], v[160:163]
    v_mfma_f32_16x16x32_bf16 v[164:167], v[32:35], v[200:203], v[164:167]
    ds_read_b128 v[196:199], v214 offset:256
    ds_read_b128 v[200:203], v214 offset:12544
    s_waitcnt lgkmcnt(6)
    v_mfma_f32_16x16x32_bf16 v[144:147], v[36:39], v[204:207], v[144:147]
    v_mfma_f32_16x16x32_bf16 v[148:151], v[40:43], v[204:207], v[148:151]
    v_mfma_f32_16x16x32_bf16 v[152:155], v[44:47], v[204:207], v[152:155]
    v_mfma_f32_16x16x32_bf16 v[156:159], v[36:39], v[208:211], v[156:159]
    v_mfma_f32_16x16x32_bf16 v[160:163], v[40:43], v[208:211], v[160:163]
    v_mfma_f32_16x16x32_bf16 v[164:167], v[44:47], v[208:211], v[164:167]
    ds_read_b128 v[204:207], v215 offset:256
    ds_read_b128 v[208:211], v215 offset:12544
    s_waitcnt lgkmcnt(6)
    v_mfma_f32_16x16x32_bf16 v[144:147], v[48:51], v[180:183], v[144:147]
    v_mfma_f32_16x16x32_bf16 v[148:151], v[52:55], v[180:183], v[148:151]
    v_mfma_f32_16x16x32_bf16 v[152:155], v[56:59], v[180:183], v[152:155]
    v_mfma_f32_16x16x32_bf16 v[156:159], v[48:51], v[184:187], v[156:159]
    v_mfma_f32_16x16x32_bf16 v[160:163], v[52:55], v[184:187], v[160:163]
    v_mfma_f32_16x16x32_bf16 v[164:167], v[56:59], v[184:187], v[164:167]
    ds_read_b128 v[180:183], v212 offset:512
    ds_read_b128 v[184:187], v212 offset:12800
    s_waitcnt lgkmcnt(6)
    v_mfma_f32_16x16x32_bf16 v[144:147], v[60:63], v[188:191], v[144:147]
    v_mfma_f32_16x16x32_bf16 v[148:151], v[64:67], v[188:191], v[148:151]
    v_mfma_f32_16x16x32_bf16 v[152:155], v[68:71], v[188:191], v[152:155]
    v_mfma_f32_16x16x32_bf16 v[156:159], v[60:63], v[192:195], v[156:159]
    v_mfma_f32_16x16x32_bf16 v[160:163], v[64:67], v[192:195], v[160:163]
    v_mfma_f32_16x16x32_bf16 v[164:167], v[68:71], v[192:195], v[164:167]
    ds_read_b128 v[188:191], v213 offset:512
    ds_read_b128 v[192:195], v213 offset:12800
    s_waitcnt lgkmcnt(6)
    v_mfma_f32_16x16x32_bf16 v[144:147], v[72:75], v[196:199], v[144:147]
    v_mfma_f32_16x16x32_bf16 v[148:151], v[76:79], v[196:199], v[148:151]
    v_mfma_f32_16x16x32_bf16 v[152:155], v[80:83], v[196:199], v[152:155]
    v_mfma_f32_16x16x32_bf16 v[156:159], v[72:75], v[200:203], v[156:159]
    v_mfma_f32_16x16x32_bf16 v[160:163], v[76:79], v[200:203], v[160:163]
    v_mfma_f32_16x16x32_bf16 v[164:167], v[80:83], v[200:203], v[164:167]
    ds_read_b128 v[196:199], v214 offset:512
    ds_read_b128 v[200:203], v214 offset:12800
    s_waitcnt lgkmcnt(6)
    v_mfma_f32_16x16x32_bf16 v[144:147], v[84:87], v[204:207], v[144:147]
    v_mfma_f32_16x16x32_bf16 v[148:151], v[88:91], v[204:207], v[148:151]
    v_mfma_f32_16x16x32_bf16 v[152:155], v[92:95], v[204:207], v[152:155]
    v_mfma_f32_16x16x32_bf16 v[156:159], v[84:87], v[208:211], v[156:159]
    v_mfma_f32_16x16x32_bf16 v[160:163], v[88:91], v[208:211], v[160:163]
    v_mfma_f32_16x16x32_bf16 v[164:167], v[92:95], v[208:211], v[164:167]
    ds_read_b128 v[204:207], v215 offset:512
    ds_read_b128 v[208:211], v215 offset:12800
    s_waitcnt lgkmcnt(6)
    v_mfma_f32_16x16x32_bf16 v[144:147], v[96:99], v[180:183], v[144:147]
    v_mfma_f32_16x16x32_bf16 v[148:151], v[100:103], v[180:183], v[148:151]
    v_mfma_f32_16x16x32_bf16 v[152:155], v[104:107], v[180:183], v[152:155]
    v_mfma_f32_16x16x32_bf16 v[156:159], v[96:99], v[184:187], v[156:159]
    v_mfma_f32_16x16x32_bf16 v[160:163], v[100:103], v[184:187], v[160:163]
    v_mfma_f32_16x16x32_bf16 v[164:167], v[104:107], v[184:187], v[164:167]
    s_waitcnt lgkmcnt(4)
    v_mfma_f32_16x16x32_bf16 v[144:147], v[108:111], v[188:191], v[144:147]
    v_mfma_f32_16x16x32_bf16 v[148:151], v[112:115], v[188:191], v[148:151]
    v_mfma_f32_16x16x32_bf16 v[152:155], v[116:119], v[188:191], v[152:155]
    v_mfma_f32_16x16x32_bf16 v[156:159], v[108:111], v[192:195], v[156:159]
    v_mfma_f32_16x16x32_bf16 v[160:163], v[112:115], v[192:195], v[160:163]
    v_mfma_f32_16x16x32_bf16 v[164:167], v[116:119], v[192:195], v[164:167]
    s_waitcnt lgkmcnt(2)
    v_mfma_f32_16x16x32_bf16 v[144:147], v[120:123], v[196:199], v[144:147]
    v_mfma_f32_16x16x32_bf16 v[148:151], v[124:127], v[196:199], v[148:151]
    v_mfma_f32_16x16x32_bf16 v[152:155], v[128:131], v[196:199], v[152:155]
    v_mfma_f32_16x16x32_bf16 v[156:159], v[120:123], v[200:203], v[156:159]
    v_mfma_f32_16x16x32_bf16 v[160:163], v[124:127], v[200:203], v[160:163]
    v_mfma_f32_16x16x32_bf16 v[164:167], v[128:131], v[200:203], v[164:167]
    s_waitcnt lgkmcnt(0)
    v_mfma_f32_16x16x32_bf16 v[144:147], v[132:135], v[204:207], v[144:147]
    v_mfma_f32_16x16x32_bf16 v[148:151], v[136:139], v[204:207], v[148:151]
    v_mfma_f32_16x16x32_bf16 v[152:155], v[140:143], v[204:207], v[152:155]
    v_mfma_f32_16x16x32_bf16 v[156:159], v[132:135], v[208:211], v[156:159]
    v_mfma_f32_16x16x32_bf16 v[160:163], v[136:139], v[208:211], v[160:163]
    v_mfma_f32_16x16x32_bf16 v[164:167], v[140:143], v[208:211], v[164:167]
    v_add_u32 v212, 4294844416, v212
    v_add_u32 v213, 4294844416, v213
    v_add_u32 v214, 4294844416, v214
    v_add_u32 v215, 4294844416, v215
    s_barrier
    ds_read_b128 v[180:183], v212 offset:0
    ds_read_b128 v[184:187], v212 offset:12288
    ds_read_b128 v[188:191], v213 offset:0
    ds_read_b128 v[192:195], v213 offset:12288
    ds_read_b128 v[196:199], v214 offset:0
    ds_read_b128 v[200:203], v214 offset:12288
    ds_read_b128 v[204:207], v215 offset:0
    ds_read_b128 v[208:211], v215 offset:12288
    s_add_u32 s34, s29, 122880
    s_add_u32 s35, s34, 12288
    v_cvt_pk_bf16_f32 v226, v144, v145
    v_cvt_pk_bf16_f32 v227, v146, v147
    v_cvt_pk_bf16_f32 v228, v148, v149
    v_cvt_pk_bf16_f32 v229, v150, v151
    v_cvt_pk_bf16_f32 v230, v152, v153
    v_cvt_pk_bf16_f32 v231, v154, v155
    buffer_store_dwordx4 v[226:229], v225, s[24:27], s34 offen
    buffer_store_dwordx2 v[230:231], v225, s[24:27], s34 offen offset:16
    v_cvt_pk_bf16_f32 v232, v156, v157
    v_cvt_pk_bf16_f32 v233, v158, v159
    v_cvt_pk_bf16_f32 v234, v160, v161
    v_cvt_pk_bf16_f32 v235, v162, v163
    v_cvt_pk_bf16_f32 v236, v164, v165
    v_cvt_pk_bf16_f32 v237, v166, v167
    buffer_store_dwordx4 v[232:235], v225, s[24:27], s35 offen
    buffer_store_dwordx2 v[236:237], v225, s[24:27], s35 offen offset:16
    s_waitcnt lgkmcnt(6)
    v_mfma_f32_16x16x32_bf16 v[144:147], v[0:3], v[180:183], v[168:171]
    v_mfma_f32_16x16x32_bf16 v[148:151], v[4:7], v[180:183], v[172:175]
    v_mfma_f32_16x16x32_bf16 v[152:155], v[8:11], v[180:183], v[176:179]
    v_mfma_f32_16x16x32_bf16 v[156:159], v[0:3], v[184:187], v[168:171]
    v_mfma_f32_16x16x32_bf16 v[160:163], v[4:7], v[184:187], v[172:175]
    v_mfma_f32_16x16x32_bf16 v[164:167], v[8:11], v[184:187], v[176:179]
    ds_read_b128 v[180:183], v212 offset:256
    ds_read_b128 v[184:187], v212 offset:12544
    s_waitcnt lgkmcnt(6)
    v_mfma_f32_16x16x32_bf16 v[144:147], v[12:15], v[188:191], v[144:147]
    v_mfma_f32_16x16x32_bf16 v[148:151], v[16:19], v[188:191], v[148:151]
    v_mfma_f32_16x16x32_bf16 v[152:155], v[20:23], v[188:191], v[152:155]
    v_mfma_f32_16x16x32_bf16 v[156:159], v[12:15], v[192:195], v[156:159]
    v_mfma_f32_16x16x32_bf16 v[160:163], v[16:19], v[192:195], v[160:163]
    v_mfma_f32_16x16x32_bf16 v[164:167], v[20:23], v[192:195], v[164:167]
    ds_read_b128 v[188:191], v213 offset:256
    ds_read_b128 v[192:195], v213 offset:12544
    s_waitcnt lgkmcnt(6)
    v_mfma_f32_16x16x32_bf16 v[144:147], v[24:27], v[196:199], v[144:147]
    v_mfma_f32_16x16x32_bf16 v[148:151], v[28:31], v[196:199], v[148:151]
    v_mfma_f32_16x16x32_bf16 v[152:155], v[32:35], v[196:199], v[152:155]
    v_mfma_f32_16x16x32_bf16 v[156:159], v[24:27], v[200:203], v[156:159]
    v_mfma_f32_16x16x32_bf16 v[160:163], v[28:31], v[200:203], v[160:163]
    v_mfma_f32_16x16x32_bf16 v[164:167], v[32:35], v[200:203], v[164:167]
    ds_read_b128 v[196:199], v214 offset:256
    ds_read_b128 v[200:203], v214 offset:12544
    s_waitcnt lgkmcnt(6)
    v_mfma_f32_16x16x32_bf16 v[144:147], v[36:39], v[204:207], v[144:147]
    v_mfma_f32_16x16x32_bf16 v[148:151], v[40:43], v[204:207], v[148:151]
    v_mfma_f32_16x16x32_bf16 v[152:155], v[44:47], v[204:207], v[152:155]
    v_mfma_f32_16x16x32_bf16 v[156:159], v[36:39], v[208:211], v[156:159]
    v_mfma_f32_16x16x32_bf16 v[160:163], v[40:43], v[208:211], v[160:163]
    v_mfma_f32_16x16x32_bf16 v[164:167], v[44:47], v[208:211], v[164:167]
    ds_read_b128 v[204:207], v215 offset:256
    ds_read_b128 v[208:211], v215 offset:12544
    s_waitcnt lgkmcnt(6)
    v_mfma_f32_16x16x32_bf16 v[144:147], v[48:51], v[180:183], v[144:147]
    v_mfma_f32_16x16x32_bf16 v[148:151], v[52:55], v[180:183], v[148:151]
    v_mfma_f32_16x16x32_bf16 v[152:155], v[56:59], v[180:183], v[152:155]
    v_mfma_f32_16x16x32_bf16 v[156:159], v[48:51], v[184:187], v[156:159]
    v_mfma_f32_16x16x32_bf16 v[160:163], v[52:55], v[184:187], v[160:163]
    v_mfma_f32_16x16x32_bf16 v[164:167], v[56:59], v[184:187], v[164:167]
    ds_read_b128 v[180:183], v212 offset:512
    ds_read_b128 v[184:187], v212 offset:12800
    s_waitcnt lgkmcnt(6)
    v_mfma_f32_16x16x32_bf16 v[144:147], v[60:63], v[188:191], v[144:147]
    v_mfma_f32_16x16x32_bf16 v[148:151], v[64:67], v[188:191], v[148:151]
    v_mfma_f32_16x16x32_bf16 v[152:155], v[68:71], v[188:191], v[152:155]
    v_mfma_f32_16x16x32_bf16 v[156:159], v[60:63], v[192:195], v[156:159]
    v_mfma_f32_16x16x32_bf16 v[160:163], v[64:67], v[192:195], v[160:163]
    v_mfma_f32_16x16x32_bf16 v[164:167], v[68:71], v[192:195], v[164:167]
    ds_read_b128 v[188:191], v213 offset:512
    ds_read_b128 v[192:195], v213 offset:12800
    s_waitcnt lgkmcnt(6)
    v_mfma_f32_16x16x32_bf16 v[144:147], v[72:75], v[196:199], v[144:147]
    v_mfma_f32_16x16x32_bf16 v[148:151], v[76:79], v[196:199], v[148:151]
    v_mfma_f32_16x16x32_bf16 v[152:155], v[80:83], v[196:199], v[152:155]
    v_mfma_f32_16x16x32_bf16 v[156:159], v[72:75], v[200:203], v[156:159]
    v_mfma_f32_16x16x32_bf16 v[160:163], v[76:79], v[200:203], v[160:163]
    v_mfma_f32_16x16x32_bf16 v[164:167], v[80:83], v[200:203], v[164:167]
    ds_read_b128 v[196:199], v214 offset:512
    ds_read_b128 v[200:203], v214 offset:12800
    s_waitcnt lgkmcnt(6)
    v_mfma_f32_16x16x32_bf16 v[144:147], v[84:87], v[204:207], v[144:147]
    v_mfma_f32_16x16x32_bf16 v[148:151], v[88:91], v[204:207], v[148:151]
    v_mfma_f32_16x16x32_bf16 v[152:155], v[92:95], v[204:207], v[152:155]
    v_mfma_f32_16x16x32_bf16 v[156:159], v[84:87], v[208:211], v[156:159]
    v_mfma_f32_16x16x32_bf16 v[160:163], v[88:91], v[208:211], v[160:163]
    v_mfma_f32_16x16x32_bf16 v[164:167], v[92:95], v[208:211], v[164:167]
    ds_read_b128 v[204:207], v215 offset:512
    ds_read_b128 v[208:211], v215 offset:12800
    s_waitcnt lgkmcnt(6)
    v_mfma_f32_16x16x32_bf16 v[144:147], v[96:99], v[180:183], v[144:147]
    v_mfma_f32_16x16x32_bf16 v[148:151], v[100:103], v[180:183], v[148:151]
    v_mfma_f32_16x16x32_bf16 v[152:155], v[104:107], v[180:183], v[152:155]
    v_mfma_f32_16x16x32_bf16 v[156:159], v[96:99], v[184:187], v[156:159]
    v_mfma_f32_16x16x32_bf16 v[160:163], v[100:103], v[184:187], v[160:163]
    v_mfma_f32_16x16x32_bf16 v[164:167], v[104:107], v[184:187], v[164:167]
    s_waitcnt lgkmcnt(4)
    v_mfma_f32_16x16x32_bf16 v[144:147], v[108:111], v[188:191], v[144:147]
    v_mfma_f32_16x16x32_bf16 v[148:151], v[112:115], v[188:191], v[148:151]
    v_mfma_f32_16x16x32_bf16 v[152:155], v[116:119], v[188:191], v[152:155]
    v_mfma_f32_16x16x32_bf16 v[156:159], v[108:111], v[192:195], v[156:159]
    v_mfma_f32_16x16x32_bf16 v[160:163], v[112:115], v[192:195], v[160:163]
    v_mfma_f32_16x16x32_bf16 v[164:167], v[116:119], v[192:195], v[164:167]
    s_waitcnt lgkmcnt(2)
    v_mfma_f32_16x16x32_bf16 v[144:147], v[120:123], v[196:199], v[144:147]
    v_mfma_f32_16x16x32_bf16 v[148:151], v[124:127], v[196:199], v[148:151]
    v_mfma_f32_16x16x32_bf16 v[152:155], v[128:131], v[196:199], v[152:155]
    v_mfma_f32_16x16x32_bf16 v[156:159], v[120:123], v[200:203], v[156:159]
    v_mfma_f32_16x16x32_bf16 v[160:163], v[124:127], v[200:203], v[160:163]
    v_mfma_f32_16x16x32_bf16 v[164:167], v[128:131], v[200:203], v[164:167]
    s_waitcnt lgkmcnt(0)
    v_mfma_f32_16x16x32_bf16 v[144:147], v[132:135], v[204:207], v[144:147]
    v_mfma_f32_16x16x32_bf16 v[148:151], v[136:139], v[204:207], v[148:151]
    v_mfma_f32_16x16x32_bf16 v[152:155], v[140:143], v[204:207], v[152:155]
    v_mfma_f32_16x16x32_bf16 v[156:159], v[132:135], v[208:211], v[156:159]
    v_mfma_f32_16x16x32_bf16 v[160:163], v[136:139], v[208:211], v[160:163]
    v_mfma_f32_16x16x32_bf16 v[164:167], v[140:143], v[208:211], v[164:167]
    v_add_u32 v212, 24576, v212
    v_add_u32 v213, 24576, v213
    v_add_u32 v214, 24576, v214
    v_add_u32 v215, 24576, v215
    s_barrier
    ds_read_b128 v[180:183], v212 offset:0
    ds_read_b128 v[184:187], v212 offset:12288
    ds_read_b128 v[188:191], v213 offset:0
    ds_read_b128 v[192:195], v213 offset:12288
    ds_read_b128 v[196:199], v214 offset:0
    ds_read_b128 v[200:203], v214 offset:12288
    ds_read_b128 v[204:207], v215 offset:0
    ds_read_b128 v[208:211], v215 offset:12288
    s_add_u32 s34, s29, 147456
    s_add_u32 s35, s34, 12288
    v_cvt_pk_bf16_f32 v226, v144, v145
    v_cvt_pk_bf16_f32 v227, v146, v147
    v_cvt_pk_bf16_f32 v228, v148, v149
    v_cvt_pk_bf16_f32 v229, v150, v151
    v_cvt_pk_bf16_f32 v230, v152, v153
    v_cvt_pk_bf16_f32 v231, v154, v155
    buffer_store_dwordx4 v[226:229], v225, s[24:27], s34 offen
    buffer_store_dwordx2 v[230:231], v225, s[24:27], s34 offen offset:16
    v_cvt_pk_bf16_f32 v232, v156, v157
    v_cvt_pk_bf16_f32 v233, v158, v159
    v_cvt_pk_bf16_f32 v234, v160, v161
    v_cvt_pk_bf16_f32 v235, v162, v163
    v_cvt_pk_bf16_f32 v236, v164, v165
    v_cvt_pk_bf16_f32 v237, v166, v167
    buffer_store_dwordx4 v[232:235], v225, s[24:27], s35 offen
    buffer_store_dwordx2 v[236:237], v225, s[24:27], s35 offen offset:16
    s_waitcnt lgkmcnt(6)
    v_mfma_f32_16x16x32_bf16 v[144:147], v[0:3], v[180:183], v[168:171]
    v_mfma_f32_16x16x32_bf16 v[148:151], v[4:7], v[180:183], v[172:175]
    v_mfma_f32_16x16x32_bf16 v[152:155], v[8:11], v[180:183], v[176:179]
    v_mfma_f32_16x16x32_bf16 v[156:159], v[0:3], v[184:187], v[168:171]
    v_mfma_f32_16x16x32_bf16 v[160:163], v[4:7], v[184:187], v[172:175]
    v_mfma_f32_16x16x32_bf16 v[164:167], v[8:11], v[184:187], v[176:179]
    ds_read_b128 v[180:183], v212 offset:256
    ds_read_b128 v[184:187], v212 offset:12544
    s_waitcnt lgkmcnt(6)
    v_mfma_f32_16x16x32_bf16 v[144:147], v[12:15], v[188:191], v[144:147]
    v_mfma_f32_16x16x32_bf16 v[148:151], v[16:19], v[188:191], v[148:151]
    v_mfma_f32_16x16x32_bf16 v[152:155], v[20:23], v[188:191], v[152:155]
    v_mfma_f32_16x16x32_bf16 v[156:159], v[12:15], v[192:195], v[156:159]
    v_mfma_f32_16x16x32_bf16 v[160:163], v[16:19], v[192:195], v[160:163]
    v_mfma_f32_16x16x32_bf16 v[164:167], v[20:23], v[192:195], v[164:167]
    ds_read_b128 v[188:191], v213 offset:256
    ds_read_b128 v[192:195], v213 offset:12544
    s_waitcnt lgkmcnt(6)
    v_mfma_f32_16x16x32_bf16 v[144:147], v[24:27], v[196:199], v[144:147]
    v_mfma_f32_16x16x32_bf16 v[148:151], v[28:31], v[196:199], v[148:151]
    v_mfma_f32_16x16x32_bf16 v[152:155], v[32:35], v[196:199], v[152:155]
    v_mfma_f32_16x16x32_bf16 v[156:159], v[24:27], v[200:203], v[156:159]
    v_mfma_f32_16x16x32_bf16 v[160:163], v[28:31], v[200:203], v[160:163]
    v_mfma_f32_16x16x32_bf16 v[164:167], v[32:35], v[200:203], v[164:167]
    ds_read_b128 v[196:199], v214 offset:256
    ds_read_b128 v[200:203], v214 offset:12544
    s_waitcnt lgkmcnt(6)
    v_mfma_f32_16x16x32_bf16 v[144:147], v[36:39], v[204:207], v[144:147]
    v_mfma_f32_16x16x32_bf16 v[148:151], v[40:43], v[204:207], v[148:151]
    v_mfma_f32_16x16x32_bf16 v[152:155], v[44:47], v[204:207], v[152:155]
    v_mfma_f32_16x16x32_bf16 v[156:159], v[36:39], v[208:211], v[156:159]
    v_mfma_f32_16x16x32_bf16 v[160:163], v[40:43], v[208:211], v[160:163]
    v_mfma_f32_16x16x32_bf16 v[164:167], v[44:47], v[208:211], v[164:167]
    ds_read_b128 v[204:207], v215 offset:256
    ds_read_b128 v[208:211], v215 offset:12544
    s_waitcnt lgkmcnt(6)
    v_mfma_f32_16x16x32_bf16 v[144:147], v[48:51], v[180:183], v[144:147]
    v_mfma_f32_16x16x32_bf16 v[148:151], v[52:55], v[180:183], v[148:151]
    v_mfma_f32_16x16x32_bf16 v[152:155], v[56:59], v[180:183], v[152:155]
    v_mfma_f32_16x16x32_bf16 v[156:159], v[48:51], v[184:187], v[156:159]
    v_mfma_f32_16x16x32_bf16 v[160:163], v[52:55], v[184:187], v[160:163]
    v_mfma_f32_16x16x32_bf16 v[164:167], v[56:59], v[184:187], v[164:167]
    ds_read_b128 v[180:183], v212 offset:512
    ds_read_b128 v[184:187], v212 offset:12800
    s_waitcnt lgkmcnt(6)
    v_mfma_f32_16x16x32_bf16 v[144:147], v[60:63], v[188:191], v[144:147]
    v_mfma_f32_16x16x32_bf16 v[148:151], v[64:67], v[188:191], v[148:151]
    v_mfma_f32_16x16x32_bf16 v[152:155], v[68:71], v[188:191], v[152:155]
    v_mfma_f32_16x16x32_bf16 v[156:159], v[60:63], v[192:195], v[156:159]
    v_mfma_f32_16x16x32_bf16 v[160:163], v[64:67], v[192:195], v[160:163]
    v_mfma_f32_16x16x32_bf16 v[164:167], v[68:71], v[192:195], v[164:167]
    ds_read_b128 v[188:191], v213 offset:512
    ds_read_b128 v[192:195], v213 offset:12800
    s_waitcnt lgkmcnt(6)
    v_mfma_f32_16x16x32_bf16 v[144:147], v[72:75], v[196:199], v[144:147]
    v_mfma_f32_16x16x32_bf16 v[148:151], v[76:79], v[196:199], v[148:151]
    v_mfma_f32_16x16x32_bf16 v[152:155], v[80:83], v[196:199], v[152:155]
    v_mfma_f32_16x16x32_bf16 v[156:159], v[72:75], v[200:203], v[156:159]
    v_mfma_f32_16x16x32_bf16 v[160:163], v[76:79], v[200:203], v[160:163]
    v_mfma_f32_16x16x32_bf16 v[164:167], v[80:83], v[200:203], v[164:167]
    ds_read_b128 v[196:199], v214 offset:512
    ds_read_b128 v[200:203], v214 offset:12800
    s_waitcnt lgkmcnt(6)
    v_mfma_f32_16x16x32_bf16 v[144:147], v[84:87], v[204:207], v[144:147]
    v_mfma_f32_16x16x32_bf16 v[148:151], v[88:91], v[204:207], v[148:151]
    v_mfma_f32_16x16x32_bf16 v[152:155], v[92:95], v[204:207], v[152:155]
    v_mfma_f32_16x16x32_bf16 v[156:159], v[84:87], v[208:211], v[156:159]
    v_mfma_f32_16x16x32_bf16 v[160:163], v[88:91], v[208:211], v[160:163]
    v_mfma_f32_16x16x32_bf16 v[164:167], v[92:95], v[208:211], v[164:167]
    ds_read_b128 v[204:207], v215 offset:512
    ds_read_b128 v[208:211], v215 offset:12800
    s_waitcnt lgkmcnt(6)
    v_mfma_f32_16x16x32_bf16 v[144:147], v[96:99], v[180:183], v[144:147]
    v_mfma_f32_16x16x32_bf16 v[148:151], v[100:103], v[180:183], v[148:151]
    v_mfma_f32_16x16x32_bf16 v[152:155], v[104:107], v[180:183], v[152:155]
    v_mfma_f32_16x16x32_bf16 v[156:159], v[96:99], v[184:187], v[156:159]
    v_mfma_f32_16x16x32_bf16 v[160:163], v[100:103], v[184:187], v[160:163]
    v_mfma_f32_16x16x32_bf16 v[164:167], v[104:107], v[184:187], v[164:167]
    s_waitcnt lgkmcnt(4)
    v_mfma_f32_16x16x32_bf16 v[144:147], v[108:111], v[188:191], v[144:147]
    v_mfma_f32_16x16x32_bf16 v[148:151], v[112:115], v[188:191], v[148:151]
    v_mfma_f32_16x16x32_bf16 v[152:155], v[116:119], v[188:191], v[152:155]
    v_mfma_f32_16x16x32_bf16 v[156:159], v[108:111], v[192:195], v[156:159]
    v_mfma_f32_16x16x32_bf16 v[160:163], v[112:115], v[192:195], v[160:163]
    v_mfma_f32_16x16x32_bf16 v[164:167], v[116:119], v[192:195], v[164:167]
    s_waitcnt lgkmcnt(2)
    v_mfma_f32_16x16x32_bf16 v[144:147], v[120:123], v[196:199], v[144:147]
    v_mfma_f32_16x16x32_bf16 v[148:151], v[124:127], v[196:199], v[148:151]
    v_mfma_f32_16x16x32_bf16 v[152:155], v[128:131], v[196:199], v[152:155]
    v_mfma_f32_16x16x32_bf16 v[156:159], v[120:123], v[200:203], v[156:159]
    v_mfma_f32_16x16x32_bf16 v[160:163], v[124:127], v[200:203], v[160:163]
    v_mfma_f32_16x16x32_bf16 v[164:167], v[128:131], v[200:203], v[164:167]
    s_waitcnt lgkmcnt(0)
    v_mfma_f32_16x16x32_bf16 v[144:147], v[132:135], v[204:207], v[144:147]
    v_mfma_f32_16x16x32_bf16 v[148:151], v[136:139], v[204:207], v[148:151]
    v_mfma_f32_16x16x32_bf16 v[152:155], v[140:143], v[204:207], v[152:155]
    v_mfma_f32_16x16x32_bf16 v[156:159], v[132:135], v[208:211], v[156:159]
    v_mfma_f32_16x16x32_bf16 v[160:163], v[136:139], v[208:211], v[160:163]
    v_mfma_f32_16x16x32_bf16 v[164:167], v[140:143], v[208:211], v[164:167]
    v_add_u32 v212, 24576, v212
    v_add_u32 v213, 24576, v213
    v_add_u32 v214, 24576, v214
    v_add_u32 v215, 24576, v215
    s_nop 7
    s_add_u32 s34, s29, 172032
    s_add_u32 s35, s34, 12288
    v_cvt_pk_bf16_f32 v226, v144, v145
    v_cvt_pk_bf16_f32 v227, v146, v147
    v_cvt_pk_bf16_f32 v228, v148, v149
    v_cvt_pk_bf16_f32 v229, v150, v151
    v_cvt_pk_bf16_f32 v230, v152, v153
    v_cvt_pk_bf16_f32 v231, v154, v155
    buffer_store_dwordx4 v[226:229], v225, s[24:27], s34 offen
    buffer_store_dwordx2 v[230:231], v225, s[24:27], s34 offen offset:16
    v_cvt_pk_bf16_f32 v232, v156, v157
    v_cvt_pk_bf16_f32 v233, v158, v159
    v_cvt_pk_bf16_f32 v234, v160, v161
    v_cvt_pk_bf16_f32 v235, v162, v163
    v_cvt_pk_bf16_f32 v236, v164, v165
    v_cvt_pk_bf16_f32 v237, v166, v167
    buffer_store_dwordx4 v[232:235], v225, s[24:27], s35 offen
    buffer_store_dwordx2 v[236:237], v225, s[24:27], s35 offen offset:16
    s_branch L_fin
L_b:
    s_and_b32 s30, s28, 3
    s_mul_i32 s30, s30, 384
    v_add_u32 v240, s30, v239
    v_lshrrev_b32 v241, 4, v240
    v_mul_u32_u24 v242, 171, v241
    v_lshrrev_b32 v242, 9, v242
    v_mul_u32_u24 v244, 48, v242
    v_sub_u32 v243, v240, v244
    v_and_b32 v244, 15, v242
    v_xor_b32 v244, v243, v244
    v_lshlrev_b32 v244, 4, v244
    v_mul_u32_u24 v216, 768, v242
    v_add_u32 v216, v216, v244
    v_add_u32 v240, s30, v239
    v_add_u32 v240, 64, v240
    v_lshrrev_b32 v241, 4, v240
    v_mul_u32_u24 v242, 171, v241
    v_lshrrev_b32 v242, 9, v242
    v_mul_u32_u24 v244, 48, v242
    v_sub_u32 v243, v240, v244
    v_and_b32 v244, 15, v242
    v_xor_b32 v244, v243, v244
    v_lshlrev_b32 v244, 4, v244
    v_mul_u32_u24 v217, 768, v242
    v_add_u32 v217, v217, v244
    v_add_u32 v240, s30, v239
    v_add_u32 v240, 128, v240
    v_lshrrev_b32 v241, 4, v240
    v_mul_u32_u24 v242, 171, v241
    v_lshrrev_b32 v242, 9, v242
    v_mul_u32_u24 v244, 48, v242
    v_sub_u32 v243, v240, v244
    v_and_b32 v244, 15, v242
    v_xor_b32 v244, v243, v244
    v_lshlrev_b32 v244, 4, v244
    v_mul_u32_u24 v218, 768, v242
    v_add_u32 v218, v218, v244
    v_add_u32 v240, s30, v239
    v_add_u32 v240, 192, v240
    v_lshrrev_b32 v241, 4, v240
    v_mul_u32_u24 v242, 171, v241
    v_lshrrev_b32 v242, 9, v242
    v_mul_u32_u24 v244, 48, v242
    v_sub_u32 v243, v240, v244
    v_and_b32 v244, 15, v242
    v_xor_b32 v244, v243, v244
    v_lshlrev_b32 v244, 4, v244
    v_mul_u32_u24 v219, 768, v242
    v_add_u32 v219, v219, v244
    v_add_u32 v240, s30, v239
    v_add_u32 v240, 256, v240
    v_lshrrev_b32 v241, 4, v240
    v_mul_u32_u24 v242, 171, v241
    v_lshrrev_b32 v242, 9, v242
    v_mul_u32_u24 v244, 48, v242
    v_sub_u32 v243, v240, v244
    v_and_b32 v244, 15, v242
    v_xor_b32 v244, v243, v244
    v_lshlrev_b32 v244, 4, v244
    v_mul_u32_u24 v220, 768, v242
    v_add_u32 v220, v220, v244
    v_add_u32 v240, s30, v239
    v_add_u32 v240, 320, v240
    v_lshrrev_b32 v241, 4, v240
    v_mul_u32_u24 v242, 171, v241
    v_lshrrev_b32 v242, 9, v242
    v_mul_u32_u24 v244, 48, v242
    v_sub_u32 v243, v240, v244
    v_and_b32 v244, 15, v242
    v_xor_b32 v244, v243, v244
    v_lshlrev_b32 v244, 4, v244
    v_mul_u32_u24 v221, 768, v242
    v_add_u32 v221, v221, v244
    v_and_b32 v240, 15, v239
    v_lshrrev_b32 v241, 4, v239
    v_add_u32 v242, 0, v241
    v_xor_b32 v242, v242, v240
    v_lshlrev_b32 v242, 4, v242
    v_mul_u32_u24 v212, 768, v240
    v_add_u32 v212, v212, v242
    v_add_u32 v242, 4, v241
    v_xor_b32 v242, v242, v240
    v_lshlrev_b32 v242, 4, v242
    v_mul_u32_u24 v213, 768, v240
    v_add_u32 v213, v213, v242
    v_add_u32 v242, 8, v241
    v_xor_b32 v242, v242, v240
    v_lshlrev_b32 v242, 4, v242
    v_mul_u32_u24 v214, 768, v240
    v_add_u32 v214, v214, v242
    v_add_u32 v242, 12, v241
    v_xor_b32 v242, v242, v240
    v_lshlrev_b32 v242, 4, v242
    v_mul_u32_u24 v215, 768, v240
    v_add_u32 v215, v215, v242
    s_mul_i32 s31, s28, 96
    v_mul_u32_u24 v225, 768, v240
    v_mul_u32_u24 v242, 24, v241
    v_add_u32 v225, v225, v242
    v_add_u32 v225, s31, v225
    v_add_u32 v243, s31, v242
    v_lshrrev_b32 v244, 2, v240
    v_and_b32 v245, 3, v240
    v_lshlrev_b32 v242, 3, v241
    v_add_u32 v242, v242, v244
    v_and_b32 v240, 1, v241
    v_lshlrev_b32 v240, 2, v240
    v_or_b32 v240, v240, v244
    v_lshlrev_b32 v240, 5, v240
    v_mul_u32_u24 v242, 768, v242
    v_mul_u32_u24 v245, 24, v245
    v_add_u32 v245, s31, v245
    v_add_u32 v222, 0, v245
    v_xor_b32 v222, v222, v240
    v_add_u32 v222, v222, v242
    v_add_u32 v222, 73728, v222
    v_add_u32 v223, 8, v245
    v_xor_b32 v223, v223, v240
    v_add_u32 v223, v223, v242
    v_add_u32 v223, 73728, v223
    v_add_u32 v224, 16, v245
    v_xor_b32 v224, v224, v240
    v_add_u32 v224, v224, v242
    v_add_u32 v224, 73728, v224
    s_and_b32 s32, s28, 3
    s_mul_i32 s32, s32, 6144
    buffer_load_dwordx4 v[226:229], v243, s[20:23], 0 offen
    buffer_load_dwordx2 v[230:231], v243, s[20:23], 0 offen offset:16
    s_add_u32 s33, s29, 0
    s_add_u32 m0, s32, 0
    s_nop 0
    buffer_load_dwordx4 v216, s[12:15], s33 offen lds
    s_add_u32 m0, s32, 1024
    s_nop 0
    buffer_load_dwordx4 v217, s[12:15], s33 offen lds
    s_add_u32 m0, s32, 2048
    s_nop 0
    buffer_load_dwordx4 v218, s[12:15], s33 offen lds
    s_add_u32 m0, s32, 3072
    s_nop 0
    buffer_load_dwordx4 v219, s[12:15], s33 offen lds
    s_add_u32 m0, s32, 4096
    s_nop 0
    buffer_load_dwordx4 v220, s[12:15], s33 offen lds
    s_add_u32 m0, s32, 5120
    s_nop 0
    buffer_load_dwordx4 v221, s[12:15], s33 offen lds
    s_add_u32 s33, s29, 24576
    s_add_u32 m0, s32, 24576
    s_nop 0
    buffer_load_dwordx4 v216, s[12:15], s33 offen lds
    s_add_u32 m0, s32, 25600
    s_nop 0
    buffer_load_dwordx4 v217, s[12:15], s33 offen lds
    s_add_u32 m0, s32, 26624
    s_nop 0
    buffer_load_dwordx4 v218, s[12:15], s33 offen lds
    s_add_u32 m0, s32, 27648
    s_nop 0
    buffer_load_dwordx4 v219, s[12:15], s33 offen lds
    s_add_u32 m0, s32, 28672
    s_nop 0
    buffer_load_dwordx4 v220, s[12:15], s33 offen lds
    s_add_u32 m0, s32, 29696
    s_nop 0
    buffer_load_dwordx4 v221, s[12:15], s33 offen lds
    s_add_u32 s33, s29, 49152
    s_add_u32 m0, s32, 49152
    s_nop 0
    buffer_load_dwordx4 v216, s[12:15], s33 offen lds
    s_add_u32 m0, s32, 50176
    s_nop 0
    buffer_load_dwordx4 v217, s[12:15], s33 offen lds
    s_add_u32 m0, s32, 51200
    s_nop 0
    buffer_load_dwordx4 v218, s[12:15], s33 offen lds
    s_add_u32 m0, s32, 52224
    s_nop 0
    buffer_load_dwordx4 v219, s[12:15], s33 offen lds
    s_add_u32 m0, s32, 53248
    s_nop 0
    buffer_load_dwordx4 v220, s[12:15], s33 offen lds
    s_add_u32 m0, s32, 54272
    s_nop 0
    buffer_load_dwordx4 v221, s[12:15], s33 offen lds
    s_waitcnt vmcnt(18)
    v_lshlrev_b32 v168, 16, v226
    v_and_b32 v169, 0xffff0000, v226
    v_lshlrev_b32 v170, 16, v227
    v_and_b32 v171, 0xffff0000, v227
    v_lshlrev_b32 v172, 16, v228
    v_and_b32 v173, 0xffff0000, v228
    v_lshlrev_b32 v174, 16, v229
    v_and_b32 v175, 0xffff0000, v229
    v_lshlrev_b32 v176, 16, v230
    v_and_b32 v177, 0xffff0000, v230
    v_lshlrev_b32 v178, 16, v231
    v_and_b32 v179, 0xffff0000, v231
    s_waitcnt vmcnt(6)
    s_barrier
    ds_read_b64_tr_b16 v[0:1], v222 offset:0
    ds_read_b64_tr_b16 v[2:3], v222 offset:3072
    ds_read_b64_tr_b16 v[4:5], v223 offset:0
    ds_read_b64_tr_b16 v[6:7], v223 offset:3072
    ds_read_b64_tr_b16 v[8:9], v224 offset:0
    ds_read_b64_tr_b16 v[10:11], v224 offset:3072
    v_add_u32 v222, 24576, v222
    v_add_u32 v223, 24576, v223
    v_add_u32 v224, 24576, v224
    ds_read_b128 v[180:183], v212 offset:0
    ds_read_b128 v[184:187], v212 offset:12288
    ds_read_b128 v[188:191], v212 offset:24576
    ds_read_b128 v[192:195], v212 offset:36864
    s_waitcnt lgkmcnt(0)
    v_mfma_f32_16x16x32_bf16 v[144:147], v[0:3], v[180:183], v[168:171]
    v_mfma_f32_16x16x32_bf16 v[148:151], v[4:7], v[180:183], v[172:175]
    v_mfma_f32_16x16x32_bf16 v[152:155], v[8:11], v[180:183], v[176:179]
    v_mfma_f32_16x16x32_bf16 v[156:159], v[0:3], v[184:187], v[168:171]
    v_mfma_f32_16x16x32_bf16 v[160:163], v[4:7], v[184:187], v[172:175]
    v_mfma_f32_16x16x32_bf16 v[164:167], v[8:11], v[184:187], v[176:179]
    v_mfma_f32_16x16x32_bf16 v[196:199], v[0:3], v[188:191], v[168:171]
    v_mfma_f32_16x16x32_bf16 v[200:203], v[4:7], v[188:191], v[172:175]
    v_mfma_f32_16x16x32_bf16 v[204:207], v[8:11], v[188:191], v[176:179]
    v_mfma_f32_16x16x32_bf16 v[208:211], v[0:3], v[192:195], v[168:171]
    v_mfma_f32_16x16x32_bf16 v[226:229], v[4:7], v[192:195], v[172:175]
    v_mfma_f32_16x16x32_bf16 v[230:233], v[8:11], v[192:195], v[176:179]
    s_barrier
    ds_read_b64_tr_b16 v[12:13], v222 offset:0
    ds_read_b64_tr_b16 v[14:15], v222 offset:3072
    ds_read_b64_tr_b16 v[16:17], v223 offset:0
    ds_read_b64_tr_b16 v[18:19], v223 offset:3072
    ds_read_b64_tr_b16 v[20:21], v224 offset:0
    ds_read_b64_tr_b16 v[22:23], v224 offset:3072
    v_add_u32 v222, 24576, v222
    v_add_u32 v223, 24576, v223
    v_add_u32 v224, 24576, v224
    ds_read_b128 v[180:183], v213 offset:0
    ds_read_b128 v[184:187], v213 offset:12288
    ds_read_b128 v[188:191], v213 offset:24576
    ds_read_b128 v[192:195], v213 offset:36864
    s_waitcnt lgkmcnt(0)
    v_mfma_f32_16x16x32_bf16 v[144:147], v[12:15], v[180:183], v[144:147]
    v_mfma_f32_16x16x32_bf16 v[148:151], v[16:19], v[180:183], v[148:151]
    v_mfma_f32_16x16x32_bf16 v[152:155], v[20:23], v[180:183], v[152:155]
    v_mfma_f32_16x16x32_bf16 v[156:159], v[12:15], v[184:187], v[156:159]
    v_mfma_f32_16x16x32_bf16 v[160:163], v[16:19], v[184:187], v[160:163]
    v_mfma_f32_16x16x32_bf16 v[164:167], v[20:23], v[184:187], v[164:167]
    v_mfma_f32_16x16x32_bf16 v[196:199], v[12:15], v[188:191], v[196:199]
    v_mfma_f32_16x16x32_bf16 v[200:203], v[16:19], v[188:191], v[200:203]
    v_mfma_f32_16x16x32_bf16 v[204:207], v[20:23], v[188:191], v[204:207]
    v_mfma_f32_16x16x32_bf16 v[208:211], v[12:15], v[192:195], v[208:211]
    v_mfma_f32_16x16x32_bf16 v[226:229], v[16:19], v[192:195], v[226:229]
    v_mfma_f32_16x16x32_bf16 v[230:233], v[20:23], v[192:195], v[230:233]
    s_barrier
    ds_read_b64_tr_b16 v[24:25], v222 offset:0
    ds_read_b64_tr_b16 v[26:27], v222 offset:3072
    ds_read_b64_tr_b16 v[28:29], v223 offset:0
    ds_read_b64_tr_b16 v[30:31], v223 offset:3072
    ds_read_b64_tr_b16 v[32:33], v224 offset:0
    ds_read_b64_tr_b16 v[34:35], v224 offset:3072
    v_add_u32 v222, 4294918144, v222
    v_add_u32 v223, 4294918144, v223
    v_add_u32 v224, 4294918144, v224
    ds_read_b128 v[180:183], v214 offset:0
    ds_read_b128 v[184:187], v214 offset:12288
    ds_read_b128 v[188:191], v214 offset:24576
    ds_read_b128 v[192:195], v214 offset:36864
    s_waitcnt lgkmcnt(0)
    v_mfma_f32_16x16x32_bf16 v[144:147], v[24:27], v[180:183], v[144:147]
    v_mfma_f32_16x16x32_bf16 v[148:151], v[28:31], v[180:183], v[148:151]
    v_mfma_f32_16x16x32_bf16 v[152:155], v[32:35], v[180:183], v[152:155]
    v_mfma_f32_16x16x32_bf16 v[156:159], v[24:27], v[184:187], v[156:159]
    v_mfma_f32_16x16x32_bf16 v[160:163], v[28:31], v[184:187], v[160:163]
    v_mfma_f32_16x16x32_bf16 v[164:167], v[32:35], v[184:187], v[164:167]
    v_mfma_f32_16x16x32_bf16 v[196:199], v[24:27], v[188:191], v[196:199]
    v_mfma_f32_16x16x32_bf16 v[200:203], v[28:31], v[188:191], v[200:203]
    v_mfma_f32_16x16x32_bf16 v[204:207], v[32:35], v[188:191], v[204:207]
    v_mfma_f32_16x16x32_bf16 v[208:211], v[24:27], v[192:195], v[208:211]
    v_mfma_f32_16x16x32_bf16 v[226:229], v[28:31], v[192:195], v[226:229]
    v_mfma_f32_16x16x32_bf16 v[230:233], v[32:35], v[192:195], v[230:233]
    s_barrier
    ds_read_b64_tr_b16 v[36:37], v222 offset:0
    ds_read_b64_tr_b16 v[38:39], v222 offset:3072
    ds_read_b64_tr_b16 v[40:41], v223 offset:0
    ds_read_b64_tr_b16 v[42:43], v223 offset:3072
    ds_read_b64_tr_b16 v[44:45], v224 offset:0
    ds_read_b64_tr_b16 v[46:47], v224 offset:3072
    v_add_u32 v222, 24576, v222
    v_add_u32 v223, 24576, v223
    v_add_u32 v224, 24576, v224
    ds_read_b128 v[180:183], v215 offset:0
    ds_read_b128 v[184:187], v215 offset:12288
    ds_read_b128 v[188:191], v215 offset:24576
    ds_read_b128 v[192:195], v215 offset:36864
    s_waitcnt lgkmcnt(0)
    v_mfma_f32_16x16x32_bf16 v[144:147], v[36:39], v[180:183], v[144:147]
    v_mfma_f32_16x16x32_bf16 v[148:151], v[40:43], v[180:183], v[148:151]
    v_mfma_f32_16x16x32_bf16 v[152:155], v[44:47], v[180:183], v[152:155]
    v_mfma_f32_16x16x32_bf16 v[156:159], v[36:39], v[184:187], v[156:159]
    v_mfma_f32_16x16x32_bf16 v[160:163], v[40:43], v[184:187], v[160:163]
    v_mfma_f32_16x16x32_bf16 v[164:167], v[44:47], v[184:187], v[164:167]
    v_mfma_f32_16x16x32_bf16 v[196:199], v[36:39], v[188:191], v[196:199]
    v_mfma_f32_16x16x32_bf16 v[200:203], v[40:43], v[188:191], v[200:203]
    v_mfma_f32_16x16x32_bf16 v[204:207], v[44:47], v[188:191], v[204:207]
    v_mfma_f32_16x16x32_bf16 v[208:211], v[36:39], v[192:195], v[208:211]
    v_mfma_f32_16x16x32_bf16 v[226:229], v[40:43], v[192:195], v[226:229]
    v_mfma_f32_16x16x32_bf16 v[230:233], v[44:47], v[192:195], v[230:233]
    s_barrier
    ds_read_b64_tr_b16 v[48:49], v222 offset:0
    ds_read_b64_tr_b16 v[50:51], v222 offset:3072
    ds_read_b64_tr_b16 v[52:53], v223 offset:0
    ds_read_b64_tr_b16 v[54:55], v223 offset:3072
    ds_read_b64_tr_b16 v[56:57], v224 offset:0
    ds_read_b64_tr_b16 v[58:59], v224 offset:3072
    v_add_u32 v222, 24576, v222
    v_add_u32 v223, 24576, v223
    v_add_u32 v224, 24576, v224
    ds_read_b128 v[180:183], v212 offset:256
    ds_read_b128 v[184:187], v212 offset:12544
    ds_read_b128 v[188:191], v212 offset:24832
    ds_read_b128 v[192:195], v212 offset:37120
    s_waitcnt lgkmcnt(0)
    v_mfma_f32_16x16x32_bf16 v[144:147], v[48:51], v[180:183], v[144:147]
    v_mfma_f32_16x16x32_bf16 v[148:151], v[52:55], v[180:183], v[148:151]
    v_mfma_f32_16x16x32_bf16 v[152:155], v[56:59], v[180:183], v[152:155]
    v_mfma_f32_16x16x32_bf16 v[156:159], v[48:51], v[184:187], v[156:159]
    v_mfma_f32_16x16x32_bf16 v[160:163], v[52:55], v[184:187], v[160:163]
    v_mfma_f32_16x16x32_bf16 v[164:167], v[56:59], v[184:187], v[164:167]
    v_mfma_f32_16x16x32_bf16 v[196:199], v[48:51], v[188:191], v[196:199]
    v_mfma_f32_16x16x32_bf16 v[200:203], v[52:55], v[188:191], v[200:203]
    v_mfma_f32_16x16x32_bf16 v[204:207], v[56:59], v[188:191], v[204:207]
    v_mfma_f32_16x16x32_bf16 v[208:211], v[48:51], v[192:195], v[208:211]
    v_mfma_f32_16x16x32_bf16 v[226:229], v[52:55], v[192:195], v[226:229]
    v_mfma_f32_16x16x32_bf16 v[230:233], v[56:59], v[192:195], v[230:233]
    s_barrier
    ds_read_b64_tr_b16 v[60:61], v222 offset:0
    ds_read_b64_tr_b16 v[62:63], v222 offset:3072
    ds_read_b64_tr_b16 v[64:65], v223 offset:0
    ds_read_b64_tr_b16 v[66:67], v223 offset:3072
    ds_read_b64_tr_b16 v[68:69], v224 offset:0
    ds_read_b64_tr_b16 v[70:71], v224 offset:3072
    v_add_u32 v222, 4294918144, v222
    v_add_u32 v223, 4294918144, v223
    v_add_u32 v224, 4294918144, v224
    ds_read_b128 v[180:183], v213 offset:256
    ds_read_b128 v[184:187], v213 offset:12544
    ds_read_b128 v[188:191], v213 offset:24832
    ds_read_b128 v[192:195], v213 offset:37120
    s_waitcnt lgkmcnt(0)
    v_mfma_f32_16x16x32_bf16 v[144:147], v[60:63], v[180:183], v[144:147]
    v_mfma_f32_16x16x32_bf16 v[148:151], v[64:67], v[180:183], v[148:151]
    v_mfma_f32_16x16x32_bf16 v[152:155], v[68:71], v[180:183], v[152:155]
    v_mfma_f32_16x16x32_bf16 v[156:159], v[60:63], v[184:187], v[156:159]
    v_mfma_f32_16x16x32_bf16 v[160:163], v[64:67], v[184:187], v[160:163]
    v_mfma_f32_16x16x32_bf16 v[164:167], v[68:71], v[184:187], v[164:167]
    v_mfma_f32_16x16x32_bf16 v[196:199], v[60:63], v[188:191], v[196:199]
    v_mfma_f32_16x16x32_bf16 v[200:203], v[64:67], v[188:191], v[200:203]
    v_mfma_f32_16x16x32_bf16 v[204:207], v[68:71], v[188:191], v[204:207]
    v_mfma_f32_16x16x32_bf16 v[208:211], v[60:63], v[192:195], v[208:211]
    v_mfma_f32_16x16x32_bf16 v[226:229], v[64:67], v[192:195], v[226:229]
    v_mfma_f32_16x16x32_bf16 v[230:233], v[68:71], v[192:195], v[230:233]
    s_barrier
    ds_read_b64_tr_b16 v[72:73], v222 offset:0
    ds_read_b64_tr_b16 v[74:75], v222 offset:3072
    ds_read_b64_tr_b16 v[76:77], v223 offset:0
    ds_read_b64_tr_b16 v[78:79], v223 offset:3072
    ds_read_b64_tr_b16 v[80:81], v224 offset:0
    ds_read_b64_tr_b16 v[82:83], v224 offset:3072
    v_add_u32 v222, 24576, v222
    v_add_u32 v223, 24576, v223
    v_add_u32 v224, 24576, v224
    ds_read_b128 v[180:183], v214 offset:256
    ds_read_b128 v[184:187], v214 offset:12544
    ds_read_b128 v[188:191], v214 offset:24832
    ds_read_b128 v[192:195], v214 offset:37120
    s_waitcnt lgkmcnt(0)
    v_mfma_f32_16x16x32_bf16 v[144:147], v[72:75], v[180:183], v[144:147]
    v_mfma_f32_16x16x32_bf16 v[148:151], v[76:79], v[180:183], v[148:151]
    v_mfma_f32_16x16x32_bf16 v[152:155], v[80:83], v[180:183], v[152:155]
    v_mfma_f32_16x16x32_bf16 v[156:159], v[72:75], v[184:187], v[156:159]
    v_mfma_f32_16x16x32_bf16 v[160:163], v[76:79], v[184:187], v[160:163]
    v_mfma_f32_16x16x32_bf16 v[164:167], v[80:83], v[184:187], v[164:167]
    v_mfma_f32_16x16x32_bf16 v[196:199], v[72:75], v[188:191], v[196:199]
    v_mfma_f32_16x16x32_bf16 v[200:203], v[76:79], v[188:191], v[200:203]
    v_mfma_f32_16x16x32_bf16 v[204:207], v[80:83], v[188:191], v[204:207]
    v_mfma_f32_16x16x32_bf16 v[208:211], v[72:75], v[192:195], v[208:211]
    v_mfma_f32_16x16x32_bf16 v[226:229], v[76:79], v[192:195], v[226:229]
    v_mfma_f32_16x16x32_bf16 v[230:233], v[80:83], v[192:195], v[230:233]
    s_barrier
    ds_read_b64_tr_b16 v[84:85], v222 offset:0
    ds_read_b64_tr_b16 v[86:87], v222 offset:3072
    ds_read_b64_tr_b16 v[88:89], v223 offset:0
    ds_read_b64_tr_b16 v[90:91], v223 offset:3072
    ds_read_b64_tr_b16 v[92:93], v224 offset:0
    ds_read_b64_tr_b16 v[94:95], v224 offset:3072
    v_add_u32 v222, 24576, v222
    v_add_u32 v223, 24576, v223
    v_add_u32 v224, 24576, v224
    ds_read_b128 v[180:183], v215 offset:256
    ds_read_b128 v[184:187], v215 offset:12544
    ds_read_b128 v[188:191], v215 offset:24832
    ds_read_b128 v[192:195], v215 offset:37120
    s_waitcnt lgkmcnt(0)
    v_mfma_f32_16x16x32_bf16 v[144:147], v[84:87], v[180:183], v[144:147]
    v_mfma_f32_16x16x32_bf16 v[148:151], v[88:91], v[180:183], v[148:151]
    v_mfma_f32_16x16x32_bf16 v[152:155], v[92:95], v[180:183], v[152:155]
    v_mfma_f32_16x16x32_bf16 v[156:159], v[84:87], v[184:187], v[156:159]
    v_mfma_f32_16x16x32_bf16 v[160:163], v[88:91], v[184:187], v[160:163]
    v_mfma_f32_16x16x32_bf16 v[164:167], v[92:95], v[184:187], v[164:167]
    v_mfma_f32_16x16x32_bf16 v[196:199], v[84:87], v[188:191], v[196:199]
    v_mfma_f32_16x16x32_bf16 v[200:203], v[88:91], v[188:191], v[200:203]
    v_mfma_f32_16x16x32_bf16 v[204:207], v[92:95], v[188:191], v[204:207]
    v_mfma_f32_16x16x32_bf16 v[208:211], v[84:87], v[192:195], v[208:211]
    v_mfma_f32_16x16x32_bf16 v[226:229], v[88:91], v[192:195], v[226:229]
    v_mfma_f32_16x16x32_bf16 v[230:233], v[92:95], v[192:195], v[230:233]
    s_barrier
    ds_read_b64_tr_b16 v[96:97], v222 offset:0
    ds_read_b64_tr_b16 v[98:99], v222 offset:3072
    ds_read_b64_tr_b16 v[100:101], v223 offset:0
    ds_read_b64_tr_b16 v[102:103], v223 offset:3072
    ds_read_b64_tr_b16 v[104:105], v224 offset:0
    ds_read_b64_tr_b16 v[106:107], v224 offset:3072
    v_add_u32 v222, 4294918144, v222
    v_add_u32 v223, 4294918144, v223
    v_add_u32 v224, 4294918144, v224
    ds_read_b128 v[180:183], v212 offset:512
    ds_read_b128 v[184:187], v212 offset:12800
    ds_read_b128 v[188:191], v212 offset:25088
    ds_read_b128 v[192:195], v212 offset:37376
    s_waitcnt lgkmcnt(0)
    v_mfma_f32_16x16x32_bf16 v[144:147], v[96:99], v[180:183], v[144:147]
    v_mfma_f32_16x16x32_bf16 v[148:151], v[100:103], v[180:183], v[148:151]
    v_mfma_f32_16x16x32_bf16 v[152:155], v[104:107], v[180:183], v[152:155]
    v_mfma_f32_16x16x32_bf16 v[156:159], v[96:99], v[184:187], v[156:159]
    v_mfma_f32_16x16x32_bf16 v[160:163], v[100:103], v[184:187], v[160:163]
    v_mfma_f32_16x16x32_bf16 v[164:167], v[104:107], v[184:187], v[164:167]
    v_mfma_f32_16x16x32_bf16 v[196:199], v[96:99], v[188:191], v[196:199]
    v_mfma_f32_16x16x32_bf16 v[200:203], v[100:103], v[188:191], v[200:203]
    v_mfma_f32_16x16x32_bf16 v[204:207], v[104:107], v[188:191], v[204:207]
    v_mfma_f32_16x16x32_bf16 v[208:211], v[96:99], v[192:195], v[208:211]
    v_mfma_f32_16x16x32_bf16 v[226:229], v[100:103], v[192:195], v[226:229]
    v_mfma_f32_16x16x32_bf16 v[230:233], v[104:107], v[192:195], v[230:233]
    s_barrier
    ds_read_b64_tr_b16 v[108:109], v222 offset:0
    ds_read_b64_tr_b16 v[110:111], v222 offset:3072
    ds_read_b64_tr_b16 v[112:113], v223 offset:0
    ds_read_b64_tr_b16 v[114:115], v223 offset:3072
    ds_read_b64_tr_b16 v[116:117], v224 offset:0
    ds_read_b64_tr_b16 v[118:119], v224 offset:3072
    v_add_u32 v222, 24576, v222
    v_add_u32 v223, 24576, v223
    v_add_u32 v224, 24576, v224
    ds_read_b128 v[180:183], v213 offset:512
    ds_read_b128 v[184:187], v213 offset:12800
    ds_read_b128 v[188:191], v213 offset:25088
    ds_read_b128 v[192:195], v213 offset:37376
    s_waitcnt lgkmcnt(0)
    v_mfma_f32_16x16x32_bf16 v[144:147], v[108:111], v[180:183], v[144:147]
    v_mfma_f32_16x16x32_bf16 v[148:151], v[112:115], v[180:183], v[148:151]
    v_mfma_f32_16x16x32_bf16 v[152:155], v[116:119], v[180:183], v[152:155]
    v_mfma_f32_16x16x32_bf16 v[156:159], v[108:111], v[184:187], v[156:159]
    v_mfma_f32_16x16x32_bf16 v[160:163], v[112:115], v[184:187], v[160:163]
    v_mfma_f32_16x16x32_bf16 v[164:167], v[116:119], v[184:187], v[164:167]
    v_mfma_f32_16x16x32_bf16 v[196:199], v[108:111], v[188:191], v[196:199]
    v_mfma_f32_16x16x32_bf16 v[200:203], v[112:115], v[188:191], v[200:203]
    v_mfma_f32_16x16x32_bf16 v[204:207], v[116:119], v[188:191], v[204:207]
    v_mfma_f32_16x16x32_bf16 v[208:211], v[108:111], v[192:195], v[208:211]
    v_mfma_f32_16x16x32_bf16 v[226:229], v[112:115], v[192:195], v[226:229]
    v_mfma_f32_16x16x32_bf16 v[230:233], v[116:119], v[192:195], v[230:233]
    s_barrier
    s_add_u32 s33, s29, 73728
    s_add_u32 m0, s32, 73728
    s_nop 0
    buffer_load_dwordx4 v216, s[12:15], s33 offen lds
    s_add_u32 m0, s32, 74752
    s_nop 0
    buffer_load_dwordx4 v217, s[12:15], s33 offen lds
    s_add_u32 m0, s32, 75776
    s_nop 0
    buffer_load_dwordx4 v218, s[12:15], s33 offen lds
    s_add_u32 m0, s32, 76800
    s_nop 0
    buffer_load_dwordx4 v219, s[12:15], s33 offen lds
    s_add_u32 m0, s32, 77824
    s_nop 0
    buffer_load_dwordx4 v220, s[12:15], s33 offen lds
    s_add_u32 m0, s32, 78848
    s_nop 0
    buffer_load_dwordx4 v221, s[12:15], s33 offen lds
    ds_read_b64_tr_b16 v[120:121], v222 offset:0
    ds_read_b64_tr_b16 v[122:123], v222 offset:3072
    ds_read_b64_tr_b16 v[124:125], v223 offset:0
    ds_read_b64_tr_b16 v[126:127], v223 offset:3072
    ds_read_b64_tr_b16 v[128:129], v224 offset:0
    ds_read_b64_tr_b16 v[130:131], v224 offset:3072
    v_add_u32 v222, 24576, v222
    v_add_u32 v223, 24576, v223
    v_add_u32 v224, 24576, v224
    ds_read_b128 v[180:183], v214 offset:512
    ds_read_b128 v[184:187], v214 offset:12800
    ds_read_b128 v[188:191], v214 offset:25088
    ds_read_b128 v[192:195], v214 offset:37376
    s_waitcnt lgkmcnt(0)
    v_mfma_f32_16x16x32_bf16 v[144:147], v[120:123], v[180:183], v[144:147]
    v_mfma_f32_16x16x32_bf16 v[148:151], v[124:127], v[180:183], v[148:151]
    v_mfma_f32_16x16x32_bf16 v[152:155], v[128:131], v[180:183], v[152:155]
    v_mfma_f32_16x16x32_bf16 v[156:159], v[120:123], v[184:187], v[156:159]
    v_mfma_f32_16x16x32_bf16 v[160:163], v[124:127], v[184:187], v[160:163]
    v_mfma_f32_16x16x32_bf16 v[164:167], v[128:131], v[184:187], v[164:167]
    v_mfma_f32_16x16x32_bf16 v[196:199], v[120:123], v[188:191], v[196:199]
    v_mfma_f32_16x16x32_bf16 v[200:203], v[124:127], v[188:191], v[200:203]
    v_mfma_f32_16x16x32_bf16 v[204:207], v[128:131], v[188:191], v[204:207]
    v_mfma_f32_16x16x32_bf16 v[208:211], v[120:123], v[192:195], v[208:211]
    v_mfma_f32_16x16x32_bf16 v[226:229], v[124:127], v[192:195], v[226:229]
    v_mfma_f32_16x16x32_bf16 v[230:233], v[128:131], v[192:195], v[230:233]
    s_barrier
    s_add_u32 s33, s29, 98304
    s_add_u32 m0, s32, 98304
    s_nop 0
    buffer_load_dwordx4 v216, s[12:15], s33 offen lds
    s_add_u32 m0, s32, 99328
    s_nop 0
    buffer_load_dwordx4 v217, s[12:15], s33 offen lds
    s_add_u32 m0, s32, 100352
    s_nop 0
    buffer_load_dwordx4 v218, s[12:15], s33 offen lds
    s_add_u32 m0, s32, 101376
    s_nop 0
    buffer_load_dwordx4 v219, s[12:15], s33 offen lds
    s_add_u32 m0, s32, 102400
    s_nop 0
    buffer_load_dwordx4 v220, s[12:15], s33 offen lds
    s_add_u32 m0, s32, 103424
    s_nop 0
    buffer_load_dwordx4 v221, s[12:15], s33 offen lds
    ds_read_b64_tr_b16 v[132:133], v222 offset:0
    ds_read_b64_tr_b16 v[134:135], v222 offset:3072
    ds_read_b64_tr_b16 v[136:137], v223 offset:0
    ds_read_b64_tr_b16 v[138:139], v223 offset:3072
    ds_read_b64_tr_b16 v[140:141], v224 offset:0
    ds_read_b64_tr_b16 v[142:143], v224 offset:3072
    v_add_u32 v222, 4294918144, v222
    v_add_u32 v223, 4294918144, v223
    v_add_u32 v224, 4294918144, v224
    ds_read_b128 v[180:183], v215 offset:512
    ds_read_b128 v[184:187], v215 offset:12800
    ds_read_b128 v[188:191], v215 offset:25088
    ds_read_b128 v[192:195], v215 offset:37376
    s_waitcnt lgkmcnt(0)
    v_mfma_f32_16x16x32_bf16 v[144:147], v[132:135], v[180:183], v[144:147]
    v_mfma_f32_16x16x32_bf16 v[148:151], v[136:139], v[180:183], v[148:151]
    v_mfma_f32_16x16x32_bf16 v[152:155], v[140:143], v[180:183], v[152:155]
    v_mfma_f32_16x16x32_bf16 v[156:159], v[132:135], v[184:187], v[156:159]
    v_mfma_f32_16x16x32_bf16 v[160:163], v[136:139], v[184:187], v[160:163]
    v_mfma_f32_16x16x32_bf16 v[164:167], v[140:143], v[184:187], v[164:167]
    v_mfma_f32_16x16x32_bf16 v[196:199], v[132:135], v[188:191], v[196:199]
    v_mfma_f32_16x16x32_bf16 v[200:203], v[136:139], v[188:191], v[200:203]
    v_mfma_f32_16x16x32_bf16 v[204:207], v[140:143], v[188:191], v[204:207]
    v_mfma_f32_16x16x32_bf16 v[208:211], v[132:135], v[192:195], v[208:211]
    v_mfma_f32_16x16x32_bf16 v[226:229], v[136:139], v[192:195], v[226:229]
    v_mfma_f32_16x16x32_bf16 v[230:233], v[140:143], v[192:195], v[230:233]
    s_nop 7
    s_add_u32 s34, s29, 24576
    s_add_u32 s35, s34, 12288
    v_cvt_pk_bf16_f32 v180, v196, v197
    v_cvt_pk_bf16_f32 v181, v198, v199
    v_cvt_pk_bf16_f32 v182, v200, v201
    v_cvt_pk_bf16_f32 v183, v202, v203
    v_cvt_pk_bf16_f32 v184, v204, v205
    v_cvt_pk_bf16_f32 v185, v206, v207
    buffer_store_dwordx4 v[180:183], v225, s[24:27], s34 offen
    buffer_store_dwordx2 v[184:185], v225, s[24:27], s34 offen offset:16
    v_cvt_pk_bf16_f32 v186, v208, v209
    v_cvt_pk_bf16_f32 v187, v210, v211
    v_cvt_pk_bf16_f32 v188, v226, v227
    v_cvt_pk_bf16_f32 v189, v228, v229
    v_cvt_pk_bf16_f32 v190, v230, v231
    v_cvt_pk_bf16_f32 v191, v232, v233
    buffer_store_dwordx4 v[186:189], v225, s[24:27], s35 offen
    buffer_store_dwordx2 v[190:191], v225, s[24:27], s35 offen offset:16
    s_nop 1
    s_add_u32 s34, s29, 0
    s_add_u32 s35, s34, 12288
    v_cvt_pk_bf16_f32 v180, v144, v145
    v_cvt_pk_bf16_f32 v181, v146, v147
    v_cvt_pk_bf16_f32 v182, v148, v149
    v_cvt_pk_bf16_f32 v183, v150, v151
    v_cvt_pk_bf16_f32 v184, v152, v153
    v_cvt_pk_bf16_f32 v185, v154, v155
    buffer_store_dwordx4 v[180:183], v225, s[24:27], s34 offen
    buffer_store_dwordx2 v[184:185], v225, s[24:27], s34 offen offset:16
    v_cvt_pk_bf16_f32 v186, v156, v157
    v_cvt_pk_bf16_f32 v187, v158, v159
    v_cvt_pk_bf16_f32 v188, v160, v161
    v_cvt_pk_bf16_f32 v189, v162, v163
    v_cvt_pk_bf16_f32 v190, v164, v165
    v_cvt_pk_bf16_f32 v191, v166, v167
    buffer_store_dwordx4 v[186:189], v225, s[24:27], s35 offen
    buffer_store_dwordx2 v[190:191], v225, s[24:27], s35 offen offset:16
    v_add_u32 v212, 49152, v212
    v_add_u32 v213, 49152, v213
    v_add_u32 v214, 49152, v214
    v_add_u32 v215, 49152, v215
    s_waitcnt vmcnt(20)
    s_barrier
    s_add_u32 s33, s29, 122880
    s_add_u32 m0, s32, 122880
    s_nop 0
    buffer_load_dwordx4 v216, s[12:15], s33 offen lds
    s_add_u32 m0, s32, 123904
    s_nop 0
    buffer_load_dwordx4 v217, s[12:15], s33 offen lds
    s_add_u32 m0, s32, 124928
    s_nop 0
    buffer_load_dwordx4 v218, s[12:15], s33 offen lds
    s_add_u32 m0, s32, 125952
    s_nop 0
    buffer_load_dwordx4 v219, s[12:15], s33 offen lds
    s_add_u32 m0, s32, 126976
    s_nop 0
    buffer_load_dwordx4 v220, s[12:15], s33 offen lds
    s_add_u32 m0, s32, 128000
    s_nop 0
    buffer_load_dwordx4 v221, s[12:15], s33 offen lds
    s_add_u32 s33, s29, 147456
    s_add_u32 m0, s32, 0
    s_nop 0
    buffer_load_dwordx4 v216, s[12:15], s33 offen lds
    s_add_u32 m0, s32, 1024
    s_nop 0
    buffer_load_dwordx4 v217, s[12:15], s33 offen lds
    s_add_u32 m0, s32, 2048
    s_nop 0
    buffer_load_dwordx4 v218, s[12:15], s33 offen lds
    s_add_u32 m0, s32, 3072
    s_nop 0
    buffer_load_dwordx4 v219, s[12:15], s33 offen lds
    s_add_u32 m0, s32, 4096
    s_nop 0
    buffer_load_dwordx4 v220, s[12:15], s33 offen lds
    s_add_u32 m0, s32, 5120
    s_nop 0
    buffer_load_dwordx4 v221, s[12:15], s33 offen lds
    ds_read_b128 v[180:183], v212 offset:0
    ds_read_b128 v[184:187], v212 offset:12288
    ds_read_b128 v[188:191], v213 offset:0
    ds_read_b128 v[192:195], v213 offset:12288
    ds_read_b128 v[196:199], v214 offset:0
    ds_read_b128 v[200:203], v214 offset:12288
    ds_read_b128 v[204:207], v215 offset:0
    ds_read_b128 v[208:211], v215 offset:12288
    s_waitcnt lgkmcnt(6)
    v_mfma_f32_16x16x32_bf16 v[144:147], v[0:3], v[180:183], v[168:171]
    v_mfma_f32_16x16x32_bf16 v[148:151], v[4:7], v[180:183], v[172:175]
    v_mfma_f32_16x16x32_bf16 v[152:155], v[8:11], v[180:183], v[176:179]
    v_mfma_f32_16x16x32_bf16 v[156:159], v[0:3], v[184:187], v[168:171]
    v_mfma_f32_16x16x32_bf16 v[160:163], v[4:7], v[184:187], v[172:175]
    v_mfma_f32_16x16x32_bf16 v[164:167], v[8:11], v[184:187], v[176:179]
    ds_read_b128 v[180:183], v212 offset:256
    ds_read_b128 v[184:187], v212 offset:12544
    s_waitcnt lgkmcnt(6)
    v_mfma_f32_16x16x32_bf16 v[144:147], v[12:15], v[188:191], v[144:147]
    v_mfma_f32_16x16x32_bf16 v[148:151], v[16:19], v[188:191], v[148:151]
    v_mfma_f32_16x16x32_bf16 v[152:155], v[20:23], v[188:191], v[152:155]
    v_mfma_f32_16x16x32_bf16 v[156:159], v[12:15], v[192:195], v[156:159]
    v_mfma_f32_16x16x32_bf16 v[160:163], v[16:19], v[192:195], v[160:163]
    v_mfma_f32_16x16x32_bf16 v[164:167], v[20:23], v[192:195], v[164:167]
    ds_read_b128 v[188:191], v213 offset:256
    ds_read_b128 v[192:195], v213 offset:12544
    s_waitcnt lgkmcnt(6)
    v_mfma_f32_16x16x32_bf16 v[144:147], v[24:27], v[196:199], v[144:147]
    v_mfma_f32_16x16x32_bf16 v[148:151], v[28:31], v[196:199], v[148:151]
    v_mfma_f32_16x16x32_bf16 v[152:155], v[32:35], v[196:199], v[152:155]
    v_mfma_f32_16x16x32_bf16 v[156:159], v[24:27], v[200:203], v[156:159]
    v_mfma_f32_16x16x32_bf16 v[160:163], v[28:31], v[200:203], v[160:163]
    v_mfma_f32_16x16x32_bf16 v[164:167], v[32:35], v[200:203], v[164:167]
    ds_read_b128 v[196:199], v214 offset:256
    ds_read_b128 v[200:203], v214 offset:12544
    s_waitcnt lgkmcnt(6)
    v_mfma_f32_16x16x32_bf16 v[144:147], v[36:39], v[204:207], v[144:147]
    v_mfma_f32_16x16x32_bf16 v[148:151], v[40:43], v[204:207], v[148:151]
    v_mfma_f32_16x16x32_bf16 v[152:155], v[44:47], v[204:207], v[152:155]
    v_mfma_f32_16x16x32_bf16 v[156:159], v[36:39], v[208:211], v[156:159]
    v_mfma_f32_16x16x32_bf16 v[160:163], v[40:43], v[208:211], v[160:163]
    v_mfma_f32_16x16x32_bf16 v[164:167], v[44:47], v[208:211], v[164:167]
    ds_read_b128 v[204:207], v215 offset:256
    ds_read_b128 v[208:211], v215 offset:12544
    s_waitcnt lgkmcnt(6)
    v_mfma_f32_16x16x32_bf16 v[144:147], v[48:51], v[180:183], v[144:147]
    v_mfma_f32_16x16x32_bf16 v[148:151], v[52:55], v[180:183], v[148:151]
    v_mfma_f32_16x16x32_bf16 v[152:155], v[56:59], v[180:183], v[152:155]
    v_mfma_f32_16x16x32_bf16 v[156:159], v[48:51], v[184:187], v[156:159]
    v_mfma_f32_16x16x32_bf16 v[160:163], v[52:55], v[184:187], v[160:163]
    v_mfma_f32_16x16x32_bf16 v[164:167], v[56:59], v[184:187], v[164:167]
    ds_read_b128 v[180:183], v212 offset:512
    ds_read_b128 v[184:187], v212 offset:12800
    s_waitcnt lgkmcnt(6)
    v_mfma_f32_16x16x32_bf16 v[144:147], v[60:63], v[188:191], v[144:147]
    v_mfma_f32_16x16x32_bf16 v[148:151], v[64:67], v[188:191], v[148:151]
    v_mfma_f32_16x16x32_bf16 v[152:155], v[68:71], v[188:191], v[152:155]
    v_mfma_f32_16x16x32_bf16 v[156:159], v[60:63], v[192:195], v[156:159]
    v_mfma_f32_16x16x32_bf16 v[160:163], v[64:67], v[192:195], v[160:163]
    v_mfma_f32_16x16x32_bf16 v[164:167], v[68:71], v[192:195], v[164:167]
    ds_read_b128 v[188:191], v213 offset:512
    ds_read_b128 v[192:195], v213 offset:12800
    s_waitcnt vmcnt(26)
    s_barrier
    s_add_u32 s33, s29, 172032
    s_add_u32 m0, s32, 24576
    s_nop 0
    buffer_load_dwordx4 v216, s[12:15], s33 offen lds
    s_add_u32 m0, s32, 25600
    s_nop 0
    buffer_load_dwordx4 v217, s[12:15], s33 offen lds
    s_add_u32 m0, s32, 26624
    s_nop 0
    buffer_load_dwordx4 v218, s[12:15], s33 offen lds
    s_add_u32 m0, s32, 27648
    s_nop 0
    buffer_load_dwordx4 v219, s[12:15], s33 offen lds
    s_add_u32 m0, s32, 28672
    s_nop 0
    buffer_load_dwordx4 v220, s[12:15], s33 offen lds
    s_add_u32 m0, s32, 29696
    s_nop 0
    buffer_load_dwordx4 v221, s[12:15], s33 offen lds
    s_waitcnt lgkmcnt(6)
    v_mfma_f32_16x16x32_bf16 v[144:147], v[72:75], v[196:199], v[144:147]
    v_mfma_f32_16x16x32_bf16 v[148:151], v[76:79], v[196:199], v[148:151]
    v_mfma_f32_16x16x32_bf16 v[152:155], v[80:83], v[196:199], v[152:155]
    v_mfma_f32_16x16x32_bf16 v[156:159], v[72:75], v[200:203], v[156:159]
    v_mfma_f32_16x16x32_bf16 v[160:163], v[76:79], v[200:203], v[160:163]
    v_mfma_f32_16x16x32_bf16 v[164:167], v[80:83], v[200:203], v[164:167]
    ds_read_b128 v[196:199], v214 offset:512
    ds_read_b128 v[200:203], v214 offset:12800
    s_waitcnt lgkmcnt(6)
    v_mfma_f32_16x16x32_bf16 v[144:147], v[84:87], v[204:207], v[144:147]
    v_mfma_f32_16x16x32_bf16 v[148:151], v[88:91], v[204:207], v[148:151]
    v_mfma_f32_16x16x32_bf16 v[152:155], v[92:95], v[204:207], v[152:155]
    v_mfma_f32_16x16x32_bf16 v[156:159], v[84:87], v[208:211], v[156:159]
    v_mfma_f32_16x16x32_bf16 v[160:163], v[88:91], v[208:211], v[160:163]
    v_mfma_f32_16x16x32_bf16 v[164:167], v[92:95], v[208:211], v[164:167]
    ds_read_b128 v[204:207], v215 offset:512
    ds_read_b128 v[208:211], v215 offset:12800
    s_waitcnt lgkmcnt(6)
    v_mfma_f32_16x16x32_bf16 v[144:147], v[96:99], v[180:183], v[144:147]
    v_mfma_f32_16x16x32_bf16 v[148:151], v[100:103], v[180:183], v[148:151]
    v_mfma_f32_16x16x32_bf16 v[152:155], v[104:107], v[180:183], v[152:155]
    v_mfma_f32_16x16x32_bf16 v[156:159], v[96:99], v[184:187], v[156:159]
    v_mfma_f32_16x16x32_bf16 v[160:163], v[100:103], v[184:187], v[160:163]
    v_mfma_f32_16x16x32_bf16 v[164:167], v[104:107], v[184:187], v[164:167]
    s_waitcnt lgkmcnt(4)
    v_mfma_f32_16x16x32_bf16 v[144:147], v[108:111], v[188:191], v[144:147]
    v_mfma_f32_16x16x32_bf16 v[148:151], v[112:115], v[188:191], v[148:151]
    v_mfma_f32_16x16x32_bf16 v[152:155], v[116:119], v[188:191], v[152:155]
    v_mfma_f32_16x16x32_bf16 v[156:159], v[108:111], v[192:195], v[156:159]
    v_mfma_f32_16x16x32_bf16 v[160:163], v[112:115], v[192:195], v[160:163]
    v_mfma_f32_16x16x32_bf16 v[164:167], v[116:119], v[192:195], v[164:167]
    s_waitcnt lgkmcnt(2)
    v_mfma_f32_16x16x32_bf16 v[144:147], v[120:123], v[196:199], v[144:147]
    v_mfma_f32_16x16x32_bf16 v[148:151], v[124:127], v[196:199], v[148:151]
    v_mfma_f32_16x16x32_bf16 v[152:155], v[128:131], v[196:199], v[152:155]
    v_mfma_f32_16x16x32_bf16 v[156:159], v[120:123], v[200:203], v[156:159]
    v_mfma_f32_16x16x32_bf16 v[160:163], v[124:127], v[200:203], v[160:163]
    v_mfma_f32_16x16x32_bf16 v[164:167], v[128:131], v[200:203], v[164:167]
    s_waitcnt lgkmcnt(0)
    v_mfma_f32_16x16x32_bf16 v[144:147], v[132:135], v[204:207], v[144:147]
    v_mfma_f32_16x16x32_bf16 v[148:151], v[136:139], v[204:207], v[148:151]
    v_mfma_f32_16x16x32_bf16 v[152:155], v[140:143], v[204:207], v[152:155]
    v_mfma_f32_16x16x32_bf16 v[156:159], v[132:135], v[208:211], v[156:159]
    v_mfma_f32_16x16x32_bf16 v[160:163], v[136:139], v[208:211], v[160:163]
    v_mfma_f32_16x16x32_bf16 v[164:167], v[140:143], v[208:211], v[164:167]
    v_add_u32 v212, 24576, v212
    v_add_u32 v213, 24576, v213
    v_add_u32 v214, 24576, v214
    v_add_u32 v215, 24576, v215
    ds_read_b128 v[180:183], v212 offset:0
    ds_read_b128 v[184:187], v212 offset:12288
    ds_read_b128 v[188:191], v213 offset:0
    ds_read_b128 v[192:195], v213 offset:12288
    ds_read_b128 v[196:199], v214 offset:0
    ds_read_b128 v[200:203], v214 offset:12288
    ds_read_b128 v[204:207], v215 offset:0
    ds_read_b128 v[208:211], v215 offset:12288
    s_add_u32 s34, s29, 49152
    s_add_u32 s35, s34, 12288
    v_cvt_pk_bf16_f32 v226, v144, v145
    v_cvt_pk_bf16_f32 v227, v146, v147
    v_cvt_pk_bf16_f32 v228, v148, v149
    v_cvt_pk_bf16_f32 v229, v150, v151
    v_cvt_pk_bf16_f32 v230, v152, v153
    v_cvt_pk_bf16_f32 v231, v154, v155
    buffer_store_dwordx4 v[226:229], v225, s[24:27], s34 offen
    buffer_store_dwordx2 v[230:231], v225, s[24:27], s34 offen offset:16
    v_cvt_pk_bf16_f32 v232, v156, v157
    v_cvt_pk_bf16_f32 v233, v158, v159
    v_cvt_pk_bf16_f32 v234, v160, v161
    v_cvt_pk_bf16_f32 v235, v162, v163
    v_cvt_pk_bf16_f32 v236, v164, v165
    v_cvt_pk_bf16_f32 v237, v166, v167
    buffer_store_dwordx4 v[232:235], v225, s[24:27], s35 offen
    buffer_store_dwordx2 v[236:237], v225, s[24:27], s35 offen offset:16
    s_waitcnt lgkmcnt(6)
    v_mfma_f32_16x16x32_bf16 v[144:147], v[0:3], v[180:183], v[168:171]
    v_mfma_f32_16x16x32_bf16 v[148:151], v[4:7], v[180:183], v[172:175]
    v_mfma_f32_16x16x32_bf16 v[152:155], v[8:11], v[180:183], v[176:179]
    v_mfma_f32_16x16x32_bf16 v[156:159], v[0:3], v[184:187], v[168:171]
    v_mfma_f32_16x16x32_bf16 v[160:163], v[4:7], v[184:187], v[172:175]
    v_mfma_f32_16x16x32_bf16 v[164:167], v[8:11], v[184:187], v[176:179]
    ds_read_b128 v[180:183], v212 offset:256
    ds_read_b128 v[184:187], v212 offset:12544
    s_waitcnt lgkmcnt(6)
    v_mfma_f32_16x16x32_bf16 v[144:147], v[12:15], v[188:191], v[144:147]
    v_mfma_f32_16x16x32_bf16 v[148:151], v[16:19], v[188:191], v[148:151]
    v_mfma_f32_16x16x32_bf16 v[152:155], v[20:23], v[188:191], v[152:155]
    v_mfma_f32_16x16x32_bf16 v[156:159], v[12:15], v[192:195], v[156:159]
    v_mfma_f32_16x16x32_bf16 v[160:163], v[16:19], v[192:195], v[160:163]
    v_mfma_f32_16x16x32_bf16 v[164:167], v[20:23], v[192:195], v[164:167]
    ds_read_b128 v[188:191], v213 offset:256
    ds_read_b128 v[192:195], v213 offset:12544
    s_waitcnt lgkmcnt(6)
    v_mfma_f32_16x16x32_bf16 v[144:147], v[24:27], v[196:199], v[144:147]
    v_mfma_f32_16x16x32_bf16 v[148:151], v[28:31], v[196:199], v[148:151]
    v_mfma_f32_16x16x32_bf16 v[152:155], v[32:35], v[196:199], v[152:155]
    v_mfma_f32_16x16x32_bf16 v[156:159], v[24:27], v[200:203], v[156:159]
    v_mfma_f32_16x16x32_bf16 v[160:163], v[28:31], v[200:203], v[160:163]
    v_mfma_f32_16x16x32_bf16 v[164:167], v[32:35], v[200:203], v[164:167]
    ds_read_b128 v[196:199], v214 offset:256
    ds_read_b128 v[200:203], v214 offset:12544
    s_waitcnt lgkmcnt(6)
    v_mfma_f32_16x16x32_bf16 v[144:147], v[36:39], v[204:207], v[144:147]
    v_mfma_f32_16x16x32_bf16 v[148:151], v[40:43], v[204:207], v[148:151]
    v_mfma_f32_16x16x32_bf16 v[152:155], v[44:47], v[204:207], v[152:155]
    v_mfma_f32_16x16x32_bf16 v[156:159], v[36:39], v[208:211], v[156:159]
    v_mfma_f32_16x16x32_bf16 v[160:163], v[40:43], v[208:211], v[160:163]
    v_mfma_f32_16x16x32_bf16 v[164:167], v[44:47], v[208:211], v[164:167]
    ds_read_b128 v[204:207], v215 offset:256
    ds_read_b128 v[208:211], v215 offset:12544
    s_waitcnt lgkmcnt(6)
    v_mfma_f32_16x16x32_bf16 v[144:147], v[48:51], v[180:183], v[144:147]
    v_mfma_f32_16x16x32_bf16 v[148:151], v[52:55], v[180:183], v[148:151]
    v_mfma_f32_16x16x32_bf16 v[152:155], v[56:59], v[180:183], v[152:155]
    v_mfma_f32_16x16x32_bf16 v[156:159], v[48:51], v[184:187], v[156:159]
    v_mfma_f32_16x16x32_bf16 v[160:163], v[52:55], v[184:187], v[160:163]
    v_mfma_f32_16x16x32_bf16 v[164:167], v[56:59], v[184:187], v[164:167]
    ds_read_b128 v[180:183], v212 offset:512
    ds_read_b128 v[184:187], v212 offset:12800
    s_waitcnt lgkmcnt(6)
    v_mfma_f32_16x16x32_bf16 v[144:147], v[60:63], v[188:191], v[144:147]
    v_mfma_f32_16x16x32_bf16 v[148:151], v[64:67], v[188:191], v[148:151]
    v_mfma_f32_16x16x32_bf16 v[152:155], v[68:71], v[188:191], v[152:155]
    v_mfma_f32_16x16x32_bf16 v[156:159], v[60:63], v[192:195], v[156:159]
    v_mfma_f32_16x16x32_bf16 v[160:163], v[64:67], v[192:195], v[160:163]
    v_mfma_f32_16x16x32_bf16 v[164:167], v[68:71], v[192:195], v[164:167]
    ds_read_b128 v[188:191], v213 offset:512
    ds_read_b128 v[192:195], v213 offset:12800
    s_waitcnt vmcnt(30)
    s_barrier
    s_waitcnt lgkmcnt(6)
    v_mfma_f32_16x16x32_bf16 v[144:147], v[72:75], v[196:199], v[144:147]
    v_mfma_f32_16x16x32_bf16 v[148:151], v[76:79], v[196:199], v[148:151]
    v_mfma_f32_16x16x32_bf16 v[152:155], v[80:83], v[196:199], v[152:155]
    v_mfma_f32_16x16x32_bf16 v[156:159], v[72:75], v[200:203], v[156:159]
    v_mfma_f32_16x16x32_bf16 v[160:163], v[76:79], v[200:203], v[160:163]
    v_mfma_f32_16x16x32_bf16 v[164:167], v[80:83], v[200:203], v[164:167]
    ds_read_b128 v[196:199], v214 offset:512
    ds_read_b128 v[200:203], v214 offset:12800
    s_waitcnt lgkmcnt(6)
    v_mfma_f32_16x16x32_bf16 v[144:147], v[84:87], v[204:207], v[144:147]
    v_mfma_f32_16x16x32_bf16 v[148:151], v[88:91], v[204:207], v[148:151]
    v_mfma_f32_16x16x32_bf16 v[152:155], v[92:95], v[204:207], v[152:155]
    v_mfma_f32_16x16x32_bf16 v[156:159], v[84:87], v[208:211], v[156:159]
    v_mfma_f32_16x16x32_bf16 v[160:163], v[88:91], v[208:211], v[160:163]
    v_mfma_f32_16x16x32_bf16 v[164:167], v[92:95], v[208:211], v[164:167]
    ds_read_b128 v[204:207], v215 offset:512
    ds_read_b128 v[208:211], v215 offset:12800
    s_waitcnt lgkmcnt(6)
    v_mfma_f32_16x16x32_bf16 v[144:147], v[96:99], v[180:183], v[144:147]
    v_mfma_f32_16x16x32_bf16 v[148:151], v[100:103], v[180:183], v[148:151]
    v_mfma_f32_16x16x32_bf16 v[152:155], v[104:107], v[180:183], v[152:155]
    v_mfma_f32_16x16x32_bf16 v[156:159], v[96:99], v[184:187], v[156:159]
    v_mfma_f32_16x16x32_bf16 v[160:163], v[100:103], v[184:187], v[160:163]
    v_mfma_f32_16x16x32_bf16 v[164:167], v[104:107], v[184:187], v[164:167]
    s_waitcnt lgkmcnt(4)
    v_mfma_f32_16x16x32_bf16 v[144:147], v[108:111], v[188:191], v[144:147]
    v_mfma_f32_16x16x32_bf16 v[148:151], v[112:115], v[188:191], v[148:151]
    v_mfma_f32_16x16x32_bf16 v[152:155], v[116:119], v[188:191], v[152:155]
    v_mfma_f32_16x16x32_bf16 v[156:159], v[108:111], v[192:195], v[156:159]
    v_mfma_f32_16x16x32_bf16 v[160:163], v[112:115], v[192:195], v[160:163]
    v_mfma_f32_16x16x32_bf16 v[164:167], v[116:119], v[192:195], v[164:167]
    s_waitcnt lgkmcnt(2)
    v_mfma_f32_16x16x32_bf16 v[144:147], v[120:123], v[196:199], v[144:147]
    v_mfma_f32_16x16x32_bf16 v[148:151], v[124:127], v[196:199], v[148:151]
    v_mfma_f32_16x16x32_bf16 v[152:155], v[128:131], v[196:199], v[152:155]
    v_mfma_f32_16x16x32_bf16 v[156:159], v[120:123], v[200:203], v[156:159]
    v_mfma_f32_16x16x32_bf16 v[160:163], v[124:127], v[200:203], v[160:163]
    v_mfma_f32_16x16x32_bf16 v[164:167], v[128:131], v[200:203], v[164:167]
    s_waitcnt lgkmcnt(0)
    v_mfma_f32_16x16x32_bf16 v[144:147], v[132:135], v[204:207], v[144:147]
    v_mfma_f32_16x16x32_bf16 v[148:151], v[136:139], v[204:207], v[148:151]
    v_mfma_f32_16x16x32_bf16 v[152:155], v[140:143], v[204:207], v[152:155]
    v_mfma_f32_16x16x32_bf16 v[156:159], v[132:135], v[208:211], v[156:159]
    v_mfma_f32_16x16x32_bf16 v[160:163], v[136:139], v[208:211], v[160:163]
    v_mfma_f32_16x16x32_bf16 v[164:167], v[140:143], v[208:211], v[164:167]
    v_add_u32 v212, 24576, v212
    v_add_u32 v213, 24576, v213
    v_add_u32 v214, 24576, v214
    v_add_u32 v215, 24576, v215
    ds_read_b128 v[180:183], v212 offset:0
    ds_read_b128 v[184:187], v212 offset:12288
    ds_read_b128 v[188:191], v213 offset:0
    ds_read_b128 v[192:195], v213 offset:12288
    ds_read_b128 v[196:199], v214 offset:0
    ds_read_b128 v[200:203], v214 offset:12288
    ds_read_b128 v[204:207], v215 offset:0
    ds_read_b128 v[208:211], v215 offset:12288
    s_add_u32 s34, s29, 73728
    s_add_u32 s35, s34, 12288
    v_cvt_pk_bf16_f32 v226, v144, v145
    v_cvt_pk_bf16_f32 v227, v146, v147
    v_cvt_pk_bf16_f32 v228, v148, v149
    v_cvt_pk_bf16_f32 v229, v150, v151
    v_cvt_pk_bf16_f32 v230, v152, v153
    v_cvt_pk_bf16_f32 v231, v154, v155
    buffer_store_dwordx4 v[226:229], v225, s[24:27], s34 offen
    buffer_store_dwordx2 v[230:231], v225, s[24:27], s34 offen offset:16
    v_cvt_pk_bf16_f32 v232, v156, v157
    v_cvt_pk_bf16_f32 v233, v158, v159
    v_cvt_pk_bf16_f32 v234, v160, v161
    v_cvt_pk_bf16_f32 v235, v162, v163
    v_cvt_pk_bf16_f32 v236, v164, v165
    v_cvt_pk_bf16_f32 v237, v166, v167
    buffer_store_dwordx4 v[232:235], v225, s[24:27], s35 offen
    buffer_store_dwordx2 v[236:237], v225, s[24:27], s35 offen offset:16
    s_waitcnt lgkmcnt(6)
    v_mfma_f32_16x16x32_bf16 v[144:147], v[0:3], v[180:183], v[168:171]
    v_mfma_f32_16x16x32_bf16 v[148:151], v[4:7], v[180:183], v[172:175]
    v_mfma_f32_16x16x32_bf16 v[152:155], v[8:11], v[180:183], v[176:179]
    v_mfma_f32_16x16x32_bf16 v[156:159], v[0:3], v[184:187], v[168:171]
    v_mfma_f32_16x16x32_bf16 v[160:163], v[4:7], v[184:187], v[172:175]
    v_mfma_f32_16x16x32_bf16 v[164:167], v[8:11], v[184:187], v[176:179]
    ds_read_b128 v[180:183], v212 offset:256
    ds_read_b128 v[184:187], v212 offset:12544
    s_waitcnt lgkmcnt(6)
    v_mfma_f32_16x16x32_bf16 v[144:147], v[12:15], v[188:191], v[144:147]
    v_mfma_f32_16x16x32_bf16 v[148:151], v[16:19], v[188:191], v[148:151]
    v_mfma_f32_16x16x32_bf16 v[152:155], v[20:23], v[188:191], v[152:155]
    v_mfma_f32_16x16x32_bf16 v[156:159], v[12:15], v[192:195], v[156:159]
    v_mfma_f32_16x16x32_bf16 v[160:163], v[16:19], v[192:195], v[160:163]
    v_mfma_f32_16x16x32_bf16 v[164:167], v[20:23], v[192:195], v[164:167]
    ds_read_b128 v[188:191], v213 offset:256
    ds_read_b128 v[192:195], v213 offset:12544
    s_waitcnt lgkmcnt(6)
    v_mfma_f32_16x16x32_bf16 v[144:147], v[24:27], v[196:199], v[144:147]
    v_mfma_f32_16x16x32_bf16 v[148:151], v[28:31], v[196:199], v[148:151]
    v_mfma_f32_16x16x32_bf16 v[152:155], v[32:35], v[196:199], v[152:155]
    v_mfma_f32_16x16x32_bf16 v[156:159], v[24:27], v[200:203], v[156:159]
    v_mfma_f32_16x16x32_bf16 v[160:163], v[28:31], v[200:203], v[160:163]
    v_mfma_f32_16x16x32_bf16 v[164:167], v[32:35], v[200:203], v[164:167]
    ds_read_b128 v[196:199], v214 offset:256
    ds_read_b128 v[200:203], v214 offset:12544
    s_waitcnt lgkmcnt(6)
    v_mfma_f32_16x16x32_bf16 v[144:147], v[36:39], v[204:207], v[144:147]
    v_mfma_f32_16x16x32_bf16 v[148:151], v[40:43], v[204:207], v[148:151]
    v_mfma_f32_16x16x32_bf16 v[152:155], v[44:47], v[204:207], v[152:155]
    v_mfma_f32_16x16x32_bf16 v[156:159], v[36:39], v[208:211], v[156:159]
    v_mfma_f32_16x16x32_bf16 v[160:163], v[40:43], v[208:211], v[160:163]
    v_mfma_f32_16x16x32_bf16 v[164:167], v[44:47], v[208:211], v[164:167]
    ds_read_b128 v[204:207], v215 offset:256
    ds_read_b128 v[208:211], v215 offset:12544
    s_waitcnt lgkmcnt(6)
    v_mfma_f32_16x16x32_bf16 v[144:147], v[48:51], v[180:183], v[144:147]
    v_mfma_f32_16x16x32_bf16 v[148:151], v[52:55], v[180:183], v[148:151]
    v_mfma_f32_16x16x32_bf16 v[152:155], v[56:59], v[180:183], v[152:155]
    v_mfma_f32_16x16x32_bf16 v[156:159], v[48:51], v[184:187], v[156:159]
    v_mfma_f32_16x16x32_bf16 v[160:163], v[52:55], v[184:187], v[160:163]
    v_mfma_f32_16x16x32_bf16 v[164:167], v[56:59], v[184:187], v[164:167]
    ds_read_b128 v[180:183], v212 offset:512
    ds_read_b128 v[184:187], v212 offset:12800
    s_waitcnt lgkmcnt(6)
    v_mfma_f32_16x16x32_bf16 v[144:147], v[60:63], v[188:191], v[144:147]
    v_mfma_f32_16x16x32_bf16 v[148:151], v[64:67], v[188:191], v[148:151]
    v_mfma_f32_16x16x32_bf16 v[152:155], v[68:71], v[188:191], v[152:155]
    v_mfma_f32_16x16x32_bf16 v[156:159], v[60:63], v[192:195], v[156:159]
    v_mfma_f32_16x16x32_bf16 v[160:163], v[64:67], v[192:195], v[160:163]
    v_mfma_f32_16x16x32_bf16 v[164:167], v[68:71], v[192:195], v[164:167]
    ds_read_b128 v[188:191], v213 offset:512
    ds_read_b128 v[192:195], v213 offset:12800
    s_waitcnt vmcnt(20)
    s_barrier
    s_waitcnt lgkmcnt(6)
    v_mfma_f32_16x16x32_bf16 v[144:147], v[72:75], v[196:199], v[144:147]
    v_mfma_f32_16x16x32_bf16 v[148:151], v[76:79], v[196:199], v[148:151]
    v_mfma_f32_16x16x32_bf16 v[152:155], v[80:83], v[196:199], v[152:155]
    v_mfma_f32_16x16x32_bf16 v[156:159], v[72:75], v[200:203], v[156:159]
    v_mfma_f32_16x16x32_bf16 v[160:163], v[76:79], v[200:203], v[160:163]
    v_mfma_f32_16x16x32_bf16 v[164:167], v[80:83], v[200:203], v[164:167]
    ds_read_b128 v[196:199], v214 offset:512
    ds_read_b128 v[200:203], v214 offset:12800
    s_waitcnt lgkmcnt(6)
    v_mfma_f32_16x16x32_bf16 v[144:147], v[84:87], v[204:207], v[144:147]
    v_mfma_f32_16x16x32_bf16 v[148:151], v[88:91], v[204:207], v[148:151]
    v_mfma_f32_16x16x32_bf16 v[152:155], v[92:95], v[204:207], v[152:155]
    v_mfma_f32_16x16x32_bf16 v[156:159], v[84:87], v[208:211], v[156:159]
    v_mfma_f32_16x16x32_bf16 v[160:163], v[88:91], v[208:211], v[160:163]
    v_mfma_f32_16x16x32_bf16 v[164:167], v[92:95], v[208:211], v[164:167]
    ds_read_b128 v[204:207], v215 offset:512
    ds_read_b128 v[208:211], v215 offset:12800
    s_waitcnt lgkmcnt(6)
    v_mfma_f32_16x16x32_bf16 v[144:147], v[96:99], v[180:183], v[144:147]
    v_mfma_f32_16x16x32_bf16 v[148:151], v[100:103], v[180:183], v[148:151]
    v_mfma_f32_16x16x32_bf16 v[152:155], v[104:107], v[180:183], v[152:155]
    v_mfma_f32_16x16x32_bf16 v[156:159], v[96:99], v[184:187], v[156:159]
    v_mfma_f32_16x16x32_bf16 v[160:163], v[100:103], v[184:187], v[160:163]
    v_mfma_f32_16x16x32_bf16 v[164:167], v[104:107], v[184:187], v[164:167]
    s_waitcnt lgkmcnt(4)
    v_mfma_f32_16x16x32_bf16 v[144:147], v[108:111], v[188:191], v[144:147]
    v_mfma_f32_16x16x32_bf16 v[148:151], v[112:115], v[188:191], v[148:151]
    v_mfma_f32_16x16x32_bf16 v[152:155], v[116:119], v[188:191], v[152:155]
    v_mfma_f32_16x16x32_bf16 v[156:159], v[108:111], v[192:195], v[156:159]
    v_mfma_f32_16x16x32_bf16 v[160:163], v[112:115], v[192:195], v[160:163]
    v_mfma_f32_16x16x32_bf16 v[164:167], v[116:119], v[192:195], v[164:167]
    s_waitcnt lgkmcnt(2)
    v_mfma_f32_16x16x32_bf16 v[144:147], v[120:123], v[196:199], v[144:147]
    v_mfma_f32_16x16x32_bf16 v[148:151], v[124:127], v[196:199], v[148:151]
    v_mfma_f32_16x16x32_bf16 v[152:155], v[128:131], v[196:199], v[152:155]
    v_mfma_f32_16x16x32_bf16 v[156:159], v[120:123], v[200:203], v[156:159]
    v_mfma_f32_16x16x32_bf16 v[160:163], v[124:127], v[200:203], v[160:163]
    v_mfma_f32_16x16x32_bf16 v[164:167], v[128:131], v[200:203], v[164:167]
    s_waitcnt lgkmcnt(0)
    v_mfma_f32_16x16x32_bf16 v[144:147], v[132:135], v[204:207], v[144:147]
    v_mfma_f32_16x16x32_bf16 v[148:151], v[136:139], v[204:207], v[148:151]
    v_mfma_f32_16x16x32_bf16 v[152:155], v[140:143], v[204:207], v[152:155]
    v_mfma_f32_16x16x32_bf16 v[156:159], v[132:135], v[208:211], v[156:159]
    v_mfma_f32_16x16x32_bf16 v[160:163], v[136:139], v[208:211], v[160:163]
    v_mfma_f32_16x16x32_bf16 v[164:167], v[140:143], v[208:211], v[164:167]
    v_add_u32 v212, 24576, v212
    v_add_u32 v213, 24576, v213
    v_add_u32 v214, 24576, v214
    v_add_u32 v215, 24576, v215
    ds_read_b128 v[180:183], v212 offset:0
    ds_read_b128 v[184:187], v212 offset:12288
    ds_read_b128 v[188:191], v213 offset:0
    ds_read_b128 v[192:195], v213 offset:12288
    ds_read_b128 v[196:199], v214 offset:0
    ds_read_b128 v[200:203], v214 offset:12288
    ds_read_b128 v[204:207], v215 offset:0
    ds_read_b128 v[208:211], v215 offset:12288
    s_add_u32 s34, s29, 98304
    s_add_u32 s35, s34, 12288
    v_cvt_pk_bf16_f32 v226, v144, v145
    v_cvt_pk_bf16_f32 v227, v146, v147
    v_cvt_pk_bf16_f32 v228, v148, v149
    v_cvt_pk_bf16_f32 v229, v150, v151
    v_cvt_pk_bf16_f32 v230, v152, v153
    v_cvt_pk_bf16_f32 v231, v154, v155
    buffer_store_dwordx4 v[226:229], v225, s[24:27], s34 offen
    buffer_store_dwordx2 v[230:231], v225, s[24:27], s34 offen offset:16
    v_cvt_pk_bf16_f32 v232, v156, v157
    v_cvt_pk_bf16_f32 v233, v158, v159
    v_cvt_pk_bf16_f32 v234, v160, v161
    v_cvt_pk_bf16_f32 v235, v162, v163
    v_cvt_pk_bf16_f32 v236, v164, v165
    v_cvt_pk_bf16_f32 v237, v166, v167
    buffer_store_dwordx4 v[232:235], v225, s[24:27], s35 offen
    buffer_store_dwordx2 v[236:237], v225, s[24:27], s35 offen offset:16
    s_waitcnt lgkmcnt(6)
    v_mfma_f32_16x16x32_bf16 v[144:147], v[0:3], v[180:183], v[168:171]
    v_mfma_f32_16x16x32_bf16 v[148:151], v[4:7], v[180:183], v[172:175]
    v_mfma_f32_16x16x32_bf16 v[152:155], v[8:11], v[180:183], v[176:179]
    v_mfma_f32_16x16x32_bf16 v[156:159], v[0:3], v[184:187], v[168:171]
    v_mfma_f32_16x16x32_bf16 v[160:163], v[4:7], v[184:187], v[172:175]
    v_mfma_f32_16x16x32_bf16 v[164:167], v[8:11], v[184:187], v[176:179]
    ds_read_b128 v[180:183], v212 offset:256
    ds_read_b128 v[184:187], v212 offset:12544
    s_waitcnt lgkmcnt(6)
    v_mfma_f32_16x16x32_bf16 v[144:147], v[12:15], v[188:191], v[144:147]
    v_mfma_f32_16x16x32_bf16 v[148:151], v[16:19], v[188:191], v[148:151]
    v_mfma_f32_16x16x32_bf16 v[152:155], v[20:23], v[188:191], v[152:155]
    v_mfma_f32_16x16x32_bf16 v[156:159], v[12:15], v[192:195], v[156:159]
    v_mfma_f32_16x16x32_bf16 v[160:163], v[16:19], v[192:195], v[160:163]
    v_mfma_f32_16x16x32_bf16 v[164:167], v[20:23], v[192:195], v[164:167]
    ds_read_b128 v[188:191], v213 offset:256
    ds_read_b128 v[192:195], v213 offset:12544
    s_waitcnt lgkmcnt(6)
    v_mfma_f32_16x16x32_bf16 v[144:147], v[24:27], v[196:199], v[144:147]
    v_mfma_f32_16x16x32_bf16 v[148:151], v[28:31], v[196:199], v[148:151]
    v_mfma_f32_16x16x32_bf16 v[152:155], v[32:35], v[196:199], v[152:155]
    v_mfma_f32_16x16x32_bf16 v[156:159], v[24:27], v[200:203], v[156:159]
    v_mfma_f32_16x16x32_bf16 v[160:163], v[28:31], v[200:203], v[160:163]
    v_mfma_f32_16x16x32_bf16 v[164:167], v[32:35], v[200:203], v[164:167]
    ds_read_b128 v[196:199], v214 offset:256
    ds_read_b128 v[200:203], v214 offset:12544
    s_waitcnt lgkmcnt(6)
    v_mfma_f32_16x16x32_bf16 v[144:147], v[36:39], v[204:207], v[144:147]
    v_mfma_f32_16x16x32_bf16 v[148:151], v[40:43], v[204:207], v[148:151]
    v_mfma_f32_16x16x32_bf16 v[152:155], v[44:47], v[204:207], v[152:155]
    v_mfma_f32_16x16x32_bf16 v[156:159], v[36:39], v[208:211], v[156:159]
    v_mfma_f32_16x16x32_bf16 v[160:163], v[40:43], v[208:211], v[160:163]
    v_mfma_f32_16x16x32_bf16 v[164:167], v[44:47], v[208:211], v[164:167]
    ds_read_b128 v[204:207], v215 offset:256
    ds_read_b128 v[208:211], v215 offset:12544
    s_waitcnt lgkmcnt(6)
    v_mfma_f32_16x16x32_bf16 v[144:147], v[48:51], v[180:183], v[144:147]
    v_mfma_f32_16x16x32_bf16 v[148:151], v[52:55], v[180:183], v[148:151]
    v_mfma_f32_16x16x32_bf16 v[152:155], v[56:59], v[180:183], v[152:155]
    v_mfma_f32_16x16x32_bf16 v[156:159], v[48:51], v[184:187], v[156:159]
    v_mfma_f32_16x16x32_bf16 v[160:163], v[52:55], v[184:187], v[160:163]
    v_mfma_f32_16x16x32_bf16 v[164:167], v[56:59], v[184:187], v[164:167]
    ds_read_b128 v[180:183], v212 offset:512
    ds_read_b128 v[184:187], v212 offset:12800
    s_waitcnt lgkmcnt(6)
    v_mfma_f32_16x16x32_bf16 v[144:147], v[60:63], v[188:191], v[144:147]
    v_mfma_f32_16x16x32_bf16 v[148:151], v[64:67], v[188:191], v[148:151]
    v_mfma_f32_16x16x32_bf16 v[152:155], v[68:71], v[188:191], v[152:155]
    v_mfma_f32_16x16x32_bf16 v[156:159], v[60:63], v[192:195], v[156:159]
    v_mfma_f32_16x16x32_bf16 v[160:163], v[64:67], v[192:195], v[160:163]
    v_mfma_f32_16x16x32_bf16 v[164:167], v[68:71], v[192:195], v[164:167]
    ds_read_b128 v[188:191], v213 offset:512
    ds_read_b128 v[192:195], v213 offset:12800
    s_waitcnt vmcnt(18)
    s_barrier
    s_waitcnt lgkmcnt(6)
    v_mfma_f32_16x16x32_bf16 v[144:147], v[72:75], v[196:199], v[144:147]
    v_mfma_f32_16x16x32_bf16 v[148:151], v[76:79], v[196:199], v[148:151]
    v_mfma_f32_16x16x32_bf16 v[152:155], v[80:83], v[196:199], v[152:155]
    v_mfma_f32_16x16x32_bf16 v[156:159], v[72:75], v[200:203], v[156:159]
    v_mfma_f32_16x16x32_bf16 v[160:163], v[76:79], v[200:203], v[160:163]
    v_mfma_f32_16x16x32_bf16 v[164:167], v[80:83], v[200:203], v[164:167]
    ds_read_b128 v[196:199], v214 offset:512
    ds_read_b128 v[200:203], v214 offset:12800
    s_waitcnt lgkmcnt(6)
    v_mfma_f32_16x16x32_bf16 v[144:147], v[84:87], v[204:207], v[144:147]
    v_mfma_f32_16x16x32_bf16 v[148:151], v[88:91], v[204:207], v[148:151]
    v_mfma_f32_16x16x32_bf16 v[152:155], v[92:95], v[204:207], v[152:155]
    v_mfma_f32_16x16x32_bf16 v[156:159], v[84:87], v[208:211], v[156:159]
    v_mfma_f32_16x16x32_bf16 v[160:163], v[88:91], v[208:211], v[160:163]
    v_mfma_f32_16x16x32_bf16 v[164:167], v[92:95], v[208:211], v[164:167]
    ds_read_b128 v[204:207], v215 offset:512
    ds_read_b128 v[208:211], v215 offset:12800
    s_waitcnt lgkmcnt(6)
    v_mfma_f32_16x16x32_bf16 v[144:147], v[96:99], v[180:183], v[144:147]
    v_mfma_f32_16x16x32_bf16 v[148:151], v[100:103], v[180:183], v[148:151]
    v_mfma_f32_16x16x32_bf16 v[152:155], v[104:107], v[180:183], v[152:155]
    v_mfma_f32_16x16x32_bf16 v[156:159], v[96:99], v[184:187], v[156:159]
    v_mfma_f32_16x16x32_bf16 v[160:163], v[100:103], v[184:187], v[160:163]
    v_mfma_f32_16x16x32_bf16 v[164:167], v[104:107], v[184:187], v[164:167]
    s_waitcnt lgkmcnt(4)
    v_mfma_f32_16x16x32_bf16 v[144:147], v[108:111], v[188:191], v[144:147]
    v_mfma_f32_16x16x32_bf16 v[148:151], v[112:115], v[188:191], v[148:151]
    v_mfma_f32_16x16x32_bf16 v[152:155], v[116:119], v[188:191], v[152:155]
    v_mfma_f32_16x16x32_bf16 v[156:159], v[108:111], v[192:195], v[156:159]
    v_mfma_f32_16x16x32_bf16 v[160:163], v[112:115], v[192:195], v[160:163]
    v_mfma_f32_16x16x32_bf16 v[164:167], v[116:119], v[192:195], v[164:167]
    s_waitcnt lgkmcnt(2)
    v_mfma_f32_16x16x32_bf16 v[144:147], v[120:123], v[196:199], v[144:147]
    v_mfma_f32_16x16x32_bf16 v[148:151], v[124:127], v[196:199], v[148:151]
    v_mfma_f32_16x16x32_bf16 v[152:155], v[128:131], v[196:199], v[152:155]
    v_mfma_f32_16x16x32_bf16 v[156:159], v[120:123], v[200:203], v[156:159]
    v_mfma_f32_16x16x32_bf16 v[160:163], v[124:127], v[200:203], v[160:163]
    v_mfma_f32_16x16x32_bf16 v[164:167], v[128:131], v[200:203], v[164:167]
    s_waitcnt lgkmcnt(0)
    v_mfma_f32_16x16x32_bf16 v[144:147], v[132:135], v[204:207], v[144:147]
    v_mfma_f32_16x16x32_bf16 v[148:151], v[136:139], v[204:207], v[148:151]
    v_mfma_f32_16x16x32_bf16 v[152:155], v[140:143], v[204:207], v[152:155]
    v_mfma_f32_16x16x32_bf16 v[156:159], v[132:135], v[208:211], v[156:159]
    v_mfma_f32_16x16x32_bf16 v[160:163], v[136:139], v[208:211], v[160:163]
    v_mfma_f32_16x16x32_bf16 v[164:167], v[140:143], v[208:211], v[164:167]
    v_add_u32 v212, 4294844416, v212
    v_add_u32 v213, 4294844416, v213
    v_add_u32 v214, 4294844416, v214
    v_add_u32 v215, 4294844416, v215
    ds_read_b128 v[180:183], v212 offset:0
    ds_read_b128 v[184:187], v212 offset:12288
    ds_read_b128 v[188:191], v213 offset:0
    ds_read_b128 v[192:195], v213 offset:12288
    ds_read_b128 v[196:199], v214 offset:0
    ds_read_b128 v[200:203], v214 offset:12288
    ds_read_b128 v[204:207], v215 offset:0
    ds_read_b128 v[208:211], v215 offset:12288
    s_add_u32 s34, s29, 122880
    s_add_u32 s35, s34, 12288
    v_cvt_pk_bf16_f32 v226, v144, v145
    v_cvt_pk_bf16_f32 v227, v146, v147
    v_cvt_pk_bf16_f32 v228, v148, v149
    v_cvt_pk_bf16_f32 v229, v150, v151
    v_cvt_pk_bf16_f32 v230, v152, v153
    v_cvt_pk_bf16_f32 v231, v154, v155
    buffer_store_dwordx4 v[226:229], v225, s[24:27], s34 offen
    buffer_store_dwordx2 v[230:231], v225, s[24:27], s34 offen offset:16
    v_cvt_pk_bf16_f32 v232, v156, v157
    v_cvt_pk_bf16_f32 v233, v158, v159
    v_cvt_pk_bf16_f32 v234, v160, v161
    v_cvt_pk_bf16_f32 v235, v162, v163
    v_cvt_pk_bf16_f32 v236, v164, v165
    v_cvt_pk_bf16_f32 v237, v166, v167
    buffer_store_dwordx4 v[232:235], v225, s[24:27], s35 offen
    buffer_store_dwordx2 v[236:237], v225, s[24:27], s35 offen offset:16
    s_waitcnt lgkmcnt(6)
    v_mfma_f32_16x16x32_bf16 v[144:147], v[0:3], v[180:183], v[168:171]
    v_mfma_f32_16x16x32_bf16 v[148:151], v[4:7], v[180:183], v[172:175]
    v_mfma_f32_16x16x32_bf16 v[152:155], v[8:11], v[180:183], v[176:179]
    v_mfma_f32_16x16x32_bf16 v[156:159], v[0:3], v[184:187], v[168:171]
    v_mfma_f32_16x16x32_bf16 v[160:163], v[4:7], v[184:187], v[172:175]
    v_mfma_f32_16x16x32_bf16 v[164:167], v[8:11], v[184:187], v[176:179]
    ds_read_b128 v[180:183], v212 offset:256
    ds_read_b128 v[184:187], v212 offset:12544
    s_waitcnt lgkmcnt(6)
    v_mfma_f32_16x16x32_bf16 v[144:147], v[12:15], v[188:191], v[144:147]
    v_mfma_f32_16x16x32_bf16 v[148:151], v[16:19], v[188:191], v[148:151]
    v_mfma_f32_16x16x32_bf16 v[152:155], v[20:23], v[188:191], v[152:155]
    v_mfma_f32_16x16x32_bf16 v[156:159], v[12:15], v[192:195], v[156:159]
    v_mfma_f32_16x16x32_bf16 v[160:163], v[16:19], v[192:195], v[160:163]
    v_mfma_f32_16x16x32_bf16 v[164:167], v[20:23], v[192:195], v[164:167]
    ds_read_b128 v[188:191], v213 offset:256
    ds_read_b128 v[192:195], v213 offset:12544
    s_waitcnt lgkmcnt(6)
    v_mfma_f32_16x16x32_bf16 v[144:147], v[24:27], v[196:199], v[144:147]
    v_mfma_f32_16x16x32_bf16 v[148:151], v[28:31], v[196:199], v[148:151]
    v_mfma_f32_16x16x32_bf16 v[152:155], v[32:35], v[196:199], v[152:155]
    v_mfma_f32_16x16x32_bf16 v[156:159], v[24:27], v[200:203], v[156:159]
    v_mfma_f32_16x16x32_bf16 v[160:163], v[28:31], v[200:203], v[160:163]
    v_mfma_f32_16x16x32_bf16 v[164:167], v[32:35], v[200:203], v[164:167]
    ds_read_b128 v[196:199], v214 offset:256
    ds_read_b128 v[200:203], v214 offset:12544
    s_waitcnt lgkmcnt(6)
    v_mfma_f32_16x16x32_bf16 v[144:147], v[36:39], v[204:207], v[144:147]
    v_mfma_f32_16x16x32_bf16 v[148:151], v[40:43], v[204:207], v[148:151]
    v_mfma_f32_16x16x32_bf16 v[152:155], v[44:47], v[204:207], v[152:155]
    v_mfma_f32_16x16x32_bf16 v[156:159], v[36:39], v[208:211], v[156:159]
    v_mfma_f32_16x16x32_bf16 v[160:163], v[40:43], v[208:211], v[160:163]
    v_mfma_f32_16x16x32_bf16 v[164:167], v[44:47], v[208:211], v[164:167]
    ds_read_b128 v[204:207], v215 offset:256
    ds_read_b128 v[208:211], v215 offset:12544
    s_waitcnt lgkmcnt(6)
    v_mfma_f32_16x16x32_bf16 v[144:147], v[48:51], v[180:183], v[144:147]
    v_mfma_f32_16x16x32_bf16 v[148:151], v[52:55], v[180:183], v[148:151]
    v_mfma_f32_16x16x32_bf16 v[152:155], v[56:59], v[180:183], v[152:155]
    v_mfma_f32_16x16x32_bf16 v[156:159], v[48:51], v[184:187], v[156:159]
    v_mfma_f32_16x16x32_bf16 v[160:163], v[52:55], v[184:187], v[160:163]
    v_mfma_f32_16x16x32_bf16 v[164:167], v[56:59], v[184:187], v[164:167]
    ds_read_b128 v[180:183], v212 offset:512
    ds_read_b128 v[184:187], v212 offset:12800
    s_waitcnt lgkmcnt(6)
    v_mfma_f32_16x16x32_bf16 v[144:147], v[60:63], v[188:191], v[144:147]
    v_mfma_f32_16x16x32_bf16 v[148:151], v[64:67], v[188:191], v[148:151]
    v_mfma_f32_16x16x32_bf16 v[152:155], v[68:71], v[188:191], v[152:155]
    v_mfma_f32_16x16x32_bf16 v[156:159], v[60:63], v[192:195], v[156:159]
    v_mfma_f32_16x16x32_bf16 v[160:163], v[64:67], v[192:195], v[160:163]
    v_mfma_f32_16x16x32_bf16 v[164:167], v[68:71], v[192:195], v[164:167]
    ds_read_b128 v[188:191], v213 offset:512
    ds_read_b128 v[192:195], v213 offset:12800
    s_waitcnt vmcnt(16)
    s_barrier
    s_waitcnt lgkmcnt(6)
    v_mfma_f32_16x16x32_bf16 v[144:147], v[72:75], v[196:199], v[144:147]
    v_mfma_f32_16x16x32_bf16 v[148:151], v[76:79], v[196:199], v[148:151]
    v_mfma_f32_16x16x32_bf16 v[152:155], v[80:83], v[196:199], v[152:155]
    v_mfma_f32_16x16x32_bf16 v[156:159], v[72:75], v[200:203], v[156:159]
    v_mfma_f32_16x16x32_bf16 v[160:163], v[76:79], v[200:203], v[160:163]
    v_mfma_f32_16x16x32_bf16 v[164:167], v[80:83], v[200:203], v[164:167]
    ds_read_b128 v[196:199], v214 offset:512
    ds_read_b128 v[200:203], v214 offset:12800
    s_waitcnt lgkmcnt(6)
    v_mfma_f32_16x16x32_bf16 v[144:147], v[84:87], v[204:207], v[144:147]
    v_mfma_f32_16x16x32_bf16 v[148:151], v[88:91], v[204:207], v[148:151]
    v_mfma_f32_16x16x32_bf16 v[152:155], v[92:95], v[204:207], v[152:155]
    v_mfma_f32_16x16x32_bf16 v[156:159], v[84:87], v[208:211], v[156:159]
    v_mfma_f32_16x16x32_bf16 v[160:163], v[88:91], v[208:211], v[160:163]
    v_mfma_f32_16x16x32_bf16 v[164:167], v[92:95], v[208:211], v[164:167]
    ds_read_b128 v[204:207], v215 offset:512
    ds_read_b128 v[208:211], v215 offset:12800
    s_waitcnt lgkmcnt(6)
    v_mfma_f32_16x16x32_bf16 v[144:147], v[96:99], v[180:183], v[144:147]
    v_mfma_f32_16x16x32_bf16 v[148:151], v[100:103], v[180:183], v[148:151]
    v_mfma_f32_16x16x32_bf16 v[152:155], v[104:107], v[180:183], v[152:155]
    v_mfma_f32_16x16x32_bf16 v[156:159], v[96:99], v[184:187], v[156:159]
    v_mfma_f32_16x16x32_bf16 v[160:163], v[100:103], v[184:187], v[160:163]
    v_mfma_f32_16x16x32_bf16 v[164:167], v[104:107], v[184:187], v[164:167]
    s_waitcnt lgkmcnt(4)
    v_mfma_f32_16x16x32_bf16 v[144:147], v[108:111], v[188:191], v[144:147]
    v_mfma_f32_16x16x32_bf16 v[148:151], v[112:115], v[188:191], v[148:151]
    v_mfma_f32_16x16x32_bf16 v[152:155], v[116:119], v[188:191], v[152:155]
    v_mfma_f32_16x16x32_bf16 v[156:159], v[108:111], v[192:195], v[156:159]
    v_mfma_f32_16x16x32_bf16 v[160:163], v[112:115], v[192:195], v[160:163]
    v_mfma_f32_16x16x32_bf16 v[164:167], v[116:119], v[192:195], v[164:167]
    s_waitcnt lgkmcnt(2)
    v_mfma_f32_16x16x32_bf16 v[144:147], v[120:123], v[196:199], v[144:147]
    v_mfma_f32_16x16x32_bf16 v[148:151], v[124:127], v[196:199], v[148:151]
    v_mfma_f32_16x16x32_bf16 v[152:155], v[128:131], v[196:199], v[152:155]
    v_mfma_f32_16x16x32_bf16 v[156:159], v[120:123], v[200:203], v[156:159]
    v_mfma_f32_16x16x32_bf16 v[160:163], v[124:127], v[200:203], v[160:163]
    v_mfma_f32_16x16x32_bf16 v[164:167], v[128:131], v[200:203], v[164:167]
    s_waitcnt lgkmcnt(0)
    v_mfma_f32_16x16x32_bf16 v[144:147], v[132:135], v[204:207], v[144:147]
    v_mfma_f32_16x16x32_bf16 v[148:151], v[136:139], v[204:207], v[148:151]
    v_mfma_f32_16x16x32_bf16 v[152:155], v[140:143], v[204:207], v[152:155]
    v_mfma_f32_16x16x32_bf16 v[156:159], v[132:135], v[208:211], v[156:159]
    v_mfma_f32_16x16x32_bf16 v[160:163], v[136:139], v[208:211], v[160:163]
    v_mfma_f32_16x16x32_bf16 v[164:167], v[140:143], v[208:211], v[164:167]
    v_add_u32 v212, 24576, v212
    v_add_u32 v213, 24576, v213
    v_add_u32 v214, 24576, v214
    v_add_u32 v215, 24576, v215
    ds_read_b128 v[180:183], v212 offset:0
    ds_read_b128 v[184:187], v212 offset:12288
    ds_read_b128 v[188:191], v213 offset:0
    ds_read_b128 v[192:195], v213 offset:12288
    ds_read_b128 v[196:199], v214 offset:0
    ds_read_b128 v[200:203], v214 offset:12288
    ds_read_b128 v[204:207], v215 offset:0
    ds_read_b128 v[208:211], v215 offset:12288
    s_add_u32 s34, s29, 147456
    s_add_u32 s35, s34, 12288
    v_cvt_pk_bf16_f32 v226, v144, v145
    v_cvt_pk_bf16_f32 v227, v146, v147
    v_cvt_pk_bf16_f32 v228, v148, v149
    v_cvt_pk_bf16_f32 v229, v150, v151
    v_cvt_pk_bf16_f32 v230, v152, v153
    v_cvt_pk_bf16_f32 v231, v154, v155
    buffer_store_dwordx4 v[226:229], v225, s[24:27], s34 offen
    buffer_store_dwordx2 v[230:231], v225, s[24:27], s34 offen offset:16
    v_cvt_pk_bf16_f32 v232, v156, v157
    v_cvt_pk_bf16_f32 v233, v158, v159
    v_cvt_pk_bf16_f32 v234, v160, v161
    v_cvt_pk_bf16_f32 v235, v162, v163
    v_cvt_pk_bf16_f32 v236, v164, v165
    v_cvt_pk_bf16_f32 v237, v166, v167
    buffer_store_dwordx4 v[232:235], v225, s[24:27], s35 offen
    buffer_store_dwordx2 v[236:237], v225, s[24:27], s35 offen offset:16
    s_waitcnt lgkmcnt(6)
    v_mfma_f32_16x16x32_bf16 v[144:147], v[0:3], v[180:183], v[168:171]
    v_mfma_f32_16x16x32_bf16 v[148:151], v[4:7], v[180:183], v[172:175]
    v_mfma_f32_16x16x32_bf16 v[152:155], v[8:11], v[180:183], v[176:179]
    v_mfma_f32_16x16x32_bf16 v[156:159], v[0:3], v[184:187], v[168:171]
    v_mfma_f32_16x16x32_bf16 v[160:163], v[4:7], v[184:187], v[172:175]
    v_mfma_f32_16x16x32_bf16 v[164:167], v[8:11], v[184:187], v[176:179]
    ds_read_b128 v[180:183], v212 offset:256
    ds_read_b128 v[184:187], v212 offset:12544
    s_waitcnt lgkmcnt(6)
    v_mfma_f32_16x16x32_bf16 v[144:147], v[12:15], v[188:191], v[144:147]
    v_mfma_f32_16x16x32_bf16 v[148:151], v[16:19], v[188:191], v[148:151]
    v_mfma_f32_16x16x32_bf16 v[152:155], v[20:23], v[188:191], v[152:155]
    v_mfma_f32_16x16x32_bf16 v[156:159], v[12:15], v[192:195], v[156:159]
    v_mfma_f32_16x16x32_bf16 v[160:163], v[16:19], v[192:195], v[160:163]
    v_mfma_f32_16x16x32_bf16 v[164:167], v[20:23], v[192:195], v[164:167]
    ds_read_b128 v[188:191], v213 offset:256
    ds_read_b128 v[192:195], v213 offset:12544
    s_waitcnt lgkmcnt(6)
    v_mfma_f32_16x16x32_bf16 v[144:147], v[24:27], v[196:199], v[144:147]
    v_mfma_f32_16x16x32_bf16 v[148:151], v[28:31], v[196:199], v[148:151]
    v_mfma_f32_16x16x32_bf16 v[152:155], v[32:35], v[196:199], v[152:155]
    v_mfma_f32_16x16x32_bf16 v[156:159], v[24:27], v[200:203], v[156:159]
    v_mfma_f32_16x16x32_bf16 v[160:163], v[28:31], v[200:203], v[160:163]
    v_mfma_f32_16x16x32_bf16 v[164:167], v[32:35], v[200:203], v[164:167]
    ds_read_b128 v[196:199], v214 offset:256
    ds_read_b128 v[200:203], v214 offset:12544
    s_waitcnt lgkmcnt(6)
    v_mfma_f32_16x16x32_bf16 v[144:147], v[36:39], v[204:207], v[144:147]
    v_mfma_f32_16x16x32_bf16 v[148:151], v[40:43], v[204:207], v[148:151]
    v_mfma_f32_16x16x32_bf16 v[152:155], v[44:47], v[204:207], v[152:155]
    v_mfma_f32_16x16x32_bf16 v[156:159], v[36:39], v[208:211], v[156:159]
    v_mfma_f32_16x16x32_bf16 v[160:163], v[40:43], v[208:211], v[160:163]
    v_mfma_f32_16x16x32_bf16 v[164:167], v[44:47], v[208:211], v[164:167]
    ds_read_b128 v[204:207], v215 offset:256
    ds_read_b128 v[208:211], v215 offset:12544
    s_waitcnt lgkmcnt(6)
    v_mfma_f32_16x16x32_bf16 v[144:147], v[48:51], v[180:183], v[144:147]
    v_mfma_f32_16x16x32_bf16 v[148:151], v[52:55], v[180:183], v[148:151]
    v_mfma_f32_16x16x32_bf16 v[152:155], v[56:59], v[180:183], v[152:155]
    v_mfma_f32_16x16x32_bf16 v[156:159], v[48:51], v[184:187], v[156:159]
    v_mfma_f32_16x16x32_bf16 v[160:163], v[52:55], v[184:187], v[160:163]
    v_mfma_f32_16x16x32_bf16 v[164:167], v[56:59], v[184:187], v[164:167]
    ds_read_b128 v[180:183], v212 offset:512
    ds_read_b128 v[184:187], v212 offset:12800
    s_waitcnt lgkmcnt(6)
    v_mfma_f32_16x16x32_bf16 v[144:147], v[60:63], v[188:191], v[144:147]
    v_mfma_f32_16x16x32_bf16 v[148:151], v[64:67], v[188:191], v[148:151]
    v_mfma_f32_16x16x32_bf16 v[152:155], v[68:71], v[188:191], v[152:155]
    v_mfma_f32_16x16x32_bf16 v[156:159], v[60:63], v[192:195], v[156:159]
    v_mfma_f32_16x16x32_bf16 v[160:163], v[64:67], v[192:195], v[160:163]
    v_mfma_f32_16x16x32_bf16 v[164:167], v[68:71], v[192:195], v[164:167]
    ds_read_b128 v[188:191], v213 offset:512
    ds_read_b128 v[192:195], v213 offset:12800
    s_waitcnt lgkmcnt(6)
    v_mfma_f32_16x16x32_bf16 v[144:147], v[72:75], v[196:199], v[144:147]
    v_mfma_f32_16x16x32_bf16 v[148:151], v[76:79], v[196:199], v[148:151]
    v_mfma_f32_16x16x32_bf16 v[152:155], v[80:83], v[196:199], v[152:155]
    v_mfma_f32_16x16x32_bf16 v[156:159], v[72:75], v[200:203], v[156:159]
    v_mfma_f32_16x16x32_bf16 v[160:163], v[76:79], v[200:203], v[160:163]
    v_mfma_f32_16x16x32_bf16 v[164:167], v[80:83], v[200:203], v[164:167]
    ds_read_b128 v[196:199], v214 offset:512
    ds_read_b128 v[200:203], v214 offset:12800
    s_waitcnt lgkmcnt(6)
    v_mfma_f32_16x16x32_bf16 v[144:147], v[84:87], v[204:207], v[144:147]
    v_mfma_f32_16x16x32_bf16 v[148:151], v[88:91], v[204:207], v[148:151]
    v_mfma_f32_16x16x32_bf16 v[152:155], v[92:95], v[204:207], v[152:155]
    v_mfma_f32_16x16x32_bf16 v[156:159], v[84:87], v[208:211], v[156:159]
    v_mfma_f32_16x16x32_bf16 v[160:163], v[88:91], v[208:211], v[160:163]
    v_mfma_f32_16x16x32_bf16 v[164:167], v[92:95], v[208:211], v[164:167]
    ds_read_b128 v[204:207], v215 offset:512
    ds_read_b128 v[208:211], v215 offset:12800
    s_waitcnt lgkmcnt(6)
    v_mfma_f32_16x16x32_bf16 v[144:147], v[96:99], v[180:183], v[144:147]
    v_mfma_f32_16x16x32_bf16 v[148:151], v[100:103], v[180:183], v[148:151]
    v_mfma_f32_16x16x32_bf16 v[152:155], v[104:107], v[180:183], v[152:155]
    v_mfma_f32_16x16x32_bf16 v[156:159], v[96:99], v[184:187], v[156:159]
    v_mfma_f32_16x16x32_bf16 v[160:163], v[100:103], v[184:187], v[160:163]
    v_mfma_f32_16x16x32_bf16 v[164:167], v[104:107], v[184:187], v[164:167]
    s_waitcnt lgkmcnt(4)
    v_mfma_f32_16x16x32_bf16 v[144:147], v[108:111], v[188:191], v[144:147]
    v_mfma_f32_16x16x32_bf16 v[148:151], v[112:115], v[188:191], v[148:151]
    v_mfma_f32_16x16x32_bf16 v[152:155], v[116:119], v[188:191], v[152:155]
    v_mfma_f32_16x16x32_bf16 v[156:159], v[108:111], v[192:195], v[156:159]
    v_mfma_f32_16x16x32_bf16 v[160:163], v[112:115], v[192:195], v[160:163]
    v_mfma_f32_16x16x32_bf16 v[164:167], v[116:119], v[192:195], v[164:167]
    s_waitcnt lgkmcnt(2)
    v_mfma_f32_16x16x32_bf16 v[144:147], v[120:123], v[196:199], v[144:147]
    v_mfma_f32_16x16x32_bf16 v[148:151], v[124:127], v[196:199], v[148:151]
    v_mfma_f32_16x16x32_bf16 v[152:155], v[128:131], v[196:199], v[152:155]
    v_mfma_f32_16x16x32_bf16 v[156:159], v[120:123], v[200:203], v[156:159]
    v_mfma_f32_16x16x32_bf16 v[160:163], v[124:127], v[200:203], v[160:163]
    v_mfma_f32_16x16x32_bf16 v[164:167], v[128:131], v[200:203], v[164:167]
    s_waitcnt lgkmcnt(0)
    v_mfma_f32_16x16x32_bf16 v[144:147], v[132:135], v[204:207], v[144:147]
    v_mfma_f32_16x16x32_bf16 v[148:151], v[136:139], v[204:207], v[148:151]
    v_mfma_f32_16x16x32_bf16 v[152:155], v[140:143], v[204:207], v[152:155]
    v_mfma_f32_16x16x32_bf16 v[156:159], v[132:135], v[208:211], v[156:159]
    v_mfma_f32_16x16x32_bf16 v[160:163], v[136:139], v[208:211], v[160:163]
    v_mfma_f32_16x16x32_bf16 v[164:167], v[140:143], v[208:211], v[164:167]
    v_add_u32 v212, 24576, v212
    v_add_u32 v213, 24576, v213
    v_add_u32 v214, 24576, v214
    v_add_u32 v215, 24576, v215
    s_nop 7
    s_add_u32 s34, s29, 172032
    s_add_u32 s35, s34, 12288
    v_cvt_pk_bf16_f32 v226, v144, v145
    v_cvt_pk_bf16_f32 v227, v146, v147
    v_cvt_pk_bf16_f32 v228, v148, v149
    v_cvt_pk_bf16_f32 v229, v150, v151
    v_cvt_pk_bf16_f32 v230, v152, v153
    v_cvt_pk_bf16_f32 v231, v154, v155
    buffer_store_dwordx4 v[226:229], v225, s[24:27], s34 offen
    buffer_store_dwordx2 v[230:231], v225, s[24:27], s34 offen offset:16
    v_cvt_pk_bf16_f32 v232, v156, v157
    v_cvt_pk_bf16_f32 v233, v158, v159
    v_cvt_pk_bf16_f32 v234, v160, v161
    v_cvt_pk_bf16_f32 v235, v162, v163
    v_cvt_pk_bf16_f32 v236, v164, v165
    v_cvt_pk_bf16_f32 v237, v166, v167
    buffer_store_dwordx4 v[232:235], v225, s[24:27], s35 offen
    buffer_store_dwordx2 v[236:237], v225, s[24:27], s35 offen offset:16
L_fin:
L_end:
    s_endpgm
.section .rodata,"a"
.p2align 6
.amdhsa_kernel standalone__standard_2d_1d_3d_conv__vision_kernel
  .amdhsa_next_free_vgpr 248
  .amdhsa_next_free_sgpr 90
  .amdhsa_accum_offset 248
  .amdhsa_group_segment_fixed_size 0
  .amdhsa_kernarg_size 48
  .amdhsa_user_sgpr_count 2
  .amdhsa_user_sgpr_kernarg_segment_ptr 1
  .amdhsa_system_sgpr_workgroup_id_x 1
.end_amdhsa_kernel
```
